```python
import torch

def _softmax(x, axis=-1):
    return torch.softmax(x, dim=axis)
def _gelu(x):
    return torch.nn.functional.gelu(x, approximate="tanh")
def _silu(x):
    return torch.nn.functional.silu(x)
def _sigmoid(x):
    return torch.sigmoid(x)
def _layernorm(x, axis=-1, eps=1e-5):
    m = x.mean(dim=axis, keepdim=True)
    v = x.var(dim=axis, keepdim=True, unbiased=False)
    return (x - m) / torch.sqrt(v + eps)
def _scatter_add(tgt, idx, src, axis=0):
    return tgt.clone().index_add_(axis, idx, src)
def _segment_sum(src, seg, n):
    out = torch.zeros((n,) + src.shape[1:], dtype=src.dtype)
    return out.index_add_(0, seg, src)
def _pad(x, pw):
    flat = tuple(v for pair in reversed(pw) for v in pair)
    return torch.nn.functional.pad(x, flat)

kernel_name = 'interleave_layers__mha_block__dense_activation_gelu__prompt'

def setup_inputs():

    _w = (lambda a: (lambda t: t.to(torch.bfloat16) if t.is_floating_point() else t)(torch.as_tensor(a)))
    def _A_setup():
        B, S, D, H = 1, 2048, 448, 16
        return {
            "x": _w((lambda *s: torch.randn(*s, dtype=torch.bfloat16) * 0.05)(B, S, D)),
            "wqkv": _w((lambda *s: torch.randn(*s, dtype=torch.bfloat16) * 0.05)(D, 3 * D)),
            "wo": _w((lambda *s: torch.randn(*s, dtype=torch.bfloat16) * 0.05)(D, D)),
        }
    _A_in = _A_setup()

    def _B_setup():
        B, S, D, F = 1, 2048, 448, 1792
        return {
            "x": _w((lambda *s: torch.randn(*s, dtype=torch.bfloat16) * 0.05)(B, S, D)),
            "w1": _w((lambda *s: torch.randn(*s, dtype=torch.bfloat16) * 0.8)(D, F) * (D ** -0.5)),
            "b1": _w((lambda *s: torch.randn(*s, dtype=torch.bfloat16) * 12.8)(F) * 0.01),
            "w2": _w((lambda *s: torch.randn(*s, dtype=torch.bfloat16) * 0.2)(F, D) * (F ** -0.5)),
            "b2": _w((lambda *s: torch.randn(*s, dtype=torch.bfloat16) * 1.6)(D) * 0.01),
        }
    _B_in = _B_setup()

    return {
        "A_x": _A_in["x"],
        "A_wqkv": _A_in["wqkv"],
        "A_wo": _A_in["wo"],
        "B_x": _B_in["x"],
        "B_w1": _B_in["w1"],
        "B_b1": _B_in["b1"],
        "B_w2": _B_in["w2"],
        "B_b2": _B_in["b2"],
    }

def reference(A_x, A_wqkv, A_wo, B_x, B_w1, B_b1, B_w2, B_b2):
    def _A_ref(x, wqkv, wo):
        B, S, D = x.shape
        H = 16
        Dh = D // H
        qkv = (lambda x, *d: x.permute(*d))((x @ wqkv).reshape(B, S, 3, H, Dh), 2, 0, 3, 1, 4)
        q, k, v = qkv[0], qkv[1], qkv[2]
        scores = torch.einsum("bhqd,bhkd->bhqk", q, k) * (Dh ** -0.5)
        p = _softmax(scores, axis=-1)
        o = torch.einsum("bhqk,bhkd->bhqd", p, v)
        return (lambda x, *d: x.permute(*d))(o, 0, 2, 1, 3).reshape(B, S, D) @ wo

    def _B_ref(x, w1, b1, w2, b2):
        h = torch.einsum("bsd,df->bsf", x, w1) + b1
        h = _gelu(h)
        return torch.einsum("bsf,fd->bsd", h, w2) + b2

    x = A_x
    x = x + _A_ref(_layernorm(x, axis=-1), A_wqkv, A_wo)
    x = x + _B_ref(_layernorm(x, axis=-1), B_w1, B_b1, B_w2, B_b2)
    x = x + _A_ref(_layernorm(x, axis=-1), A_wqkv, A_wo)
    x = x + _B_ref(_layernorm(x, axis=-1), B_w1, B_b1, B_w2, B_b2)
    return x
```

```asm
; @launch grid=(256,1,1) block=(256,1,1) lds=163840
.amdgcn_target "amdgcn-amd-amdhsa--gfx950"
.text
.globl interleave_layers__mha_block__dense_activation_gelu__prompt_kernel
.p2align 8
.type interleave_layers__mha_block__dense_activation_gelu__prompt_kernel,@function
interleave_layers__mha_block__dense_activation_gelu__prompt_kernel:
  s_cmp_ge_u32 s2, 256
  s_cbranch_scc1 main_end
  s_getpc_b64 s[56:57]
cp_pc:
  v_lshlrev_b32 v1, 7, v0
  s_sub_u32 s56, s56, cp_pc-interleave_layers__mha_block__dense_activation_gelu__prompt_kernel
  s_subb_u32 s57, s57, 0
  global_load_dword v254, v1, s[56:57]
  s_load_dwordx2 s[4:5], s[0:1], 80
  s_load_dwordx2 s[52:53], s[0:1], 72
  s_load_dwordx16 s[36:51], s[0:1], 0
  v_add_u32 v1, 0x8000, v1
  v_cmp_gt_u32 vcc, main_code_end-interleave_layers__mha_block__dense_activation_gelu__prompt_kernel, v1
  s_and_saveexec_b64 s[58:59], vcc
  s_cbranch_execz cp_skip
  global_load_dword v253, v1, s[56:57]
cp_skip:
  s_mov_b64 exec, s[58:59]
  v_lshrrev_b32 v1, 6, v0
  v_and_b32 v0, 63, v0
  v_readfirstlane_b32 s3, v1
  s_mov_b32 s6, 0x2800000
  s_mov_b32 s7, 0x20000
  s_mov_b32 s54, 256
  s_mov_b32 s55, 0x20000
  s_waitcnt lgkmcnt(0)
  s_and_b32 s5, s5, 0xffff
  s_and_b32 s53, s53, 0xffff
  s_or_b32 s58, s2, s3
  s_cmp_lg_u32 s58, 0
  s_cbranch_scc1 nonce_done
  s_memrealtime s[58:59]
  s_waitcnt lgkmcnt(0)
  s_lshl_b32 s58, s58, 4
  s_or_b32 s58, s58, 8
  v_mov_b32 v6, s58
  v_mov_b32 v7, 0
  s_mov_b64 exec, 1
  buffer_store_dword v6, v7, s[52:55], 0 offen sc0 sc1
  s_mov_b64 exec, -1
nonce_done:
  v_and_b32 v2, 31, v0
  v_lshrrev_b32 v3, 5, v0
  v_lshlrev_b32 v4, 4, v0
  s_cmp_ge_u32 s2, 252
  s_cbranch_scc1 prep_done
  s_cmp_ge_u32 s2, 188
  s_cbranch_scc1 prep_x
  v_lshrrev_b32 v8, 2, v0
  v_and_b32 v9, 3, v0
  v_lshlrev_b32 v9, 4, v9
  v_and_b32 v7, 15, v0
  v_lshrrev_b32 v7, 2, v7
  v_lshl_add_u32 v7, v3, 2, v7
  v_lshlrev_b32 v7, 6, v7
  v_bfe_u32 v10, v0, 4, 1
  v_lshl_add_u32 v7, v10, 5, v7
  v_and_b32 v10, 3, v0
  v_lshl_add_u32 v7, v10, 3, v7
  s_cmp_ge_u32 s2, 160
  s_cbranch_scc1 prep_wo
  s_cmp_ge_u32 s2, 104
  s_cbranch_scc1 prep_w2
  s_cmp_ge_u32 s2, 48
  s_cbranch_scc1 prep_w1
  s_mov_b32 s8, s38
  s_mov_b32 s9, s39
  s_mov_b32 s10, 1204224
  s_mov_b32 s11, 0x20000
  s_mul_i32 s24, s2, 21846
  s_lshr_b32 s24, s24, 16
  s_mul_i32 s25, s24, 3
  s_sub_u32 s25, s2, s25
  s_mul_i32 s26, s25, 896
  s_mul_i32 s27, s24, 56
  s_add_u32 s26, s26, s27
  s_and_b32 s27, s24, 1
  s_lshl_b32 s27, s27, 3
  s_sub_u32 s26, s26, s27
  v_add_u32 v7, s27, v7
  s_mul_i32 s27, s3, 301056
  s_add_u32 s20, s26, s27
  v_mul_u32_u24 v5, 2688, v8
  v_add_u32 v5, v5, v9
  s_mul_i32 s21, s24, 86016
  s_mul_i32 s27, s3, 21504
  s_add_u32 s21, s21, s27
  s_lshl_b32 s27, s25, 10
  s_add_u32 s21, s21, s27
  s_add_u32 s21, s21, 0x0
  s_lshl_b32 s28, s2, 7
  s_add_u32 s28, s28, 0x4d0000
  s_waitcnt lgkmcnt(0)
  s_and_b32 s9, s9, 0xffff
  s_mul_i32 s23, s3, 7168
  s_add_u32 m0, s23, 0
  s_add_u32 s22, s20, 0
  buffer_load_dwordx4 v5, s[8:11], s22 offen lds
  s_add_u32 m0, s23, 1024
  s_add_u32 s22, s20, 43008
  buffer_load_dwordx4 v5, s[8:11], s22 offen lds
  s_add_u32 m0, s23, 2048
  s_add_u32 s22, s20, 86016
  buffer_load_dwordx4 v5, s[8:11], s22 offen lds
  s_add_u32 m0, s23, 3072
  s_add_u32 s22, s20, 129024
  buffer_load_dwordx4 v5, s[8:11], s22 offen lds
  s_add_u32 m0, s23, 4096
  s_add_u32 s22, s20, 172032
  buffer_load_dwordx4 v5, s[8:11], s22 offen lds
  s_add_u32 m0, s23, 5120
  s_add_u32 s22, s20, 215040
  buffer_load_dwordx4 v5, s[8:11], s22 offen lds
  s_add_u32 m0, s23, 6144
  s_add_u32 s22, s20, 258048
  buffer_load_dwordx4 v5, s[8:11], s22 offen lds
  v_add_u32 v7, s23, v7
  v_mov_b32 v12, 0
  v_mov_b32 v13, 0x3f803f80
  s_waitcnt vmcnt(6)
  ds_read_b64_tr_b16 v[16:17], v7 offset:0
  ds_read_b64_tr_b16 v[18:19], v7 offset:512
  s_waitcnt vmcnt(5)
  ds_read_b64_tr_b16 v[20:21], v7 offset:1024
  ds_read_b64_tr_b16 v[22:23], v7 offset:1536
  s_waitcnt vmcnt(4)
  ds_read_b64_tr_b16 v[24:25], v7 offset:2048
  ds_read_b64_tr_b16 v[26:27], v7 offset:2560
  s_waitcnt vmcnt(3)
  ds_read_b64_tr_b16 v[28:29], v7 offset:3072
  ds_read_b64_tr_b16 v[30:31], v7 offset:3584
  s_waitcnt vmcnt(2)
  ds_read_b64_tr_b16 v[32:33], v7 offset:4096
  ds_read_b64_tr_b16 v[34:35], v7 offset:4608
  s_waitcnt vmcnt(1)
  ds_read_b64_tr_b16 v[36:37], v7 offset:5120
  ds_read_b64_tr_b16 v[38:39], v7 offset:5632
  s_waitcnt vmcnt(0)
  ds_read_b64_tr_b16 v[40:41], v7 offset:6144
  ds_read_b64_tr_b16 v[42:43], v7 offset:6656
  s_waitcnt lgkmcnt(0)
  v_cmp_gt_u32 vcc, 28, v2
  s_nop 1
  v_cndmask_b32 v16, 0, v16, vcc
  v_cndmask_b32 v17, 0, v17, vcc
  v_cndmask_b32 v18, 0, v18, vcc
  v_cndmask_b32 v19, 0, v19, vcc
  v_cndmask_b32 v20, 0, v20, vcc
  v_cndmask_b32 v21, 0, v21, vcc
  v_cndmask_b32 v22, 0, v22, vcc
  v_cndmask_b32 v23, 0, v23, vcc
  v_cndmask_b32 v24, 0, v24, vcc
  v_cndmask_b32 v25, 0, v25, vcc
  v_cndmask_b32 v26, 0, v26, vcc
  v_cndmask_b32 v27, 0, v27, vcc
  v_cndmask_b32 v28, 0, v28, vcc
  v_cndmask_b32 v29, 0, v29, vcc
  v_cndmask_b32 v30, 0, v30, vcc
  v_cndmask_b32 v31, 0, v31, vcc
  v_cndmask_b32 v32, 0, v32, vcc
  v_cndmask_b32 v33, 0, v33, vcc
  v_cndmask_b32 v34, 0, v34, vcc
  v_cndmask_b32 v35, 0, v35, vcc
  v_cndmask_b32 v36, 0, v36, vcc
  v_cndmask_b32 v37, 0, v37, vcc
  v_cndmask_b32 v38, 0, v38, vcc
  v_cndmask_b32 v39, 0, v39, vcc
  v_cndmask_b32 v40, 0, v40, vcc
  v_cndmask_b32 v41, 0, v41, vcc
  v_cndmask_b32 v42, 0, v42, vcc
  v_cndmask_b32 v43, 0, v43, vcc
  s_add_u32 s22, s21, 0
  buffer_store_dwordx4 v[16:19], v4, s[4:7], s22 offen sc1
  s_add_u32 s22, s21, 3072
  buffer_store_dwordx4 v[20:23], v4, s[4:7], s22 offen sc1
  s_add_u32 s22, s21, 6144
  buffer_store_dwordx4 v[24:27], v4, s[4:7], s22 offen sc1
  s_add_u32 s22, s21, 9216
  buffer_store_dwordx4 v[28:31], v4, s[4:7], s22 offen sc1
  s_add_u32 s22, s21, 12288
  buffer_store_dwordx4 v[32:35], v4, s[4:7], s22 offen sc1
  s_add_u32 s22, s21, 15360
  buffer_store_dwordx4 v[36:39], v4, s[4:7], s22 offen sc1
  s_add_u32 s22, s21, 18432
  buffer_store_dwordx4 v[40:43], v4, s[4:7], s22 offen sc1
  v_dot2_f32_bf16 v12, v16, v13, v12
  v_dot2_f32_bf16 v12, v17, v13, v12
  v_dot2_f32_bf16 v12, v18, v13, v12
  v_dot2_f32_bf16 v12, v19, v13, v12
  v_dot2_f32_bf16 v12, v20, v13, v12
  v_dot2_f32_bf16 v12, v21, v13, v12
  v_dot2_f32_bf16 v12, v22, v13, v12
  v_dot2_f32_bf16 v12, v23, v13, v12
  v_dot2_f32_bf16 v12, v24, v13, v12
  v_dot2_f32_bf16 v12, v25, v13, v12
  v_dot2_f32_bf16 v12, v26, v13, v12
  v_dot2_f32_bf16 v12, v27, v13, v12
  v_dot2_f32_bf16 v12, v28, v13, v12
  v_dot2_f32_bf16 v12, v29, v13, v12
  v_dot2_f32_bf16 v12, v30, v13, v12
  v_dot2_f32_bf16 v12, v31, v13, v12
  v_dot2_f32_bf16 v12, v32, v13, v12
  v_dot2_f32_bf16 v12, v33, v13, v12
  v_dot2_f32_bf16 v12, v34, v13, v12
  v_dot2_f32_bf16 v12, v35, v13, v12
  v_dot2_f32_bf16 v12, v36, v13, v12
  v_dot2_f32_bf16 v12, v37, v13, v12
  v_dot2_f32_bf16 v12, v38, v13, v12
  v_dot2_f32_bf16 v12, v39, v13, v12
  v_dot2_f32_bf16 v12, v40, v13, v12
  v_dot2_f32_bf16 v12, v41, v13, v12
  v_dot2_f32_bf16 v12, v42, v13, v12
  v_dot2_f32_bf16 v12, v43, v13, v12
  s_nop 3
  v_mov_b32 v14, v12
  s_nop 1
  v_permlane32_swap_b32 v12, v14
  s_nop 1
  v_add_f32 v12, v12, v14
  s_lshl_b32 s23, s3, 7
  s_add_u32 s23, s23, 28672
  v_lshlrev_b32 v11, 2, v2
  v_add_u32 v14, s23, v11
  ds_write_b32 v14, v12
  s_waitcnt lgkmcnt(0)
  s_barrier
  ds_read_b32 v12, v11 offset:28672
  ds_read_b32 v13, v11 offset:28800
  ds_read_b32 v14, v11 offset:28928
  ds_read_b32 v15, v11 offset:29056
  s_waitcnt lgkmcnt(0)
  v_add_f32 v12, v12, v13
  v_add_f32 v14, v14, v15
  v_add_f32 v12, v12, v14
  s_cmp_lg_u32 s3, 0
  s_cbranch_scc1 prep_q_done
  buffer_store_dword v12, v11, s[4:7], s28 offen sc1
prep_q_done:
  s_branch prep_done
prep_w1:
  s_mov_b32 s8, s44
  s_mov_b32 s9, s45
  s_mov_b32 s10, 1605632
  s_mov_b32 s11, 0x20000
  s_mov_b32 s12, s46
  s_mov_b32 s13, s47
  s_mov_b32 s14, 3584
  s_mov_b32 s15, 0x20000
  s_sub_u32 s24, s2, 48
  s_lshl_b32 s26, s24, 6
  s_mul_i32 s27, s3, 401408
  s_add_u32 s20, s26, s27
  v_mul_u32_u24 v5, 3584, v8
  v_add_u32 v5, v5, v9
  s_lshr_b32 s25, s24, 2
  s_mul_i32 s21, s25, 114688
  s_mul_i32 s27, s3, 28672
  s_add_u32 s21, s21, s27
  s_and_b32 s27, s24, 3
  s_lshl_b32 s27, s27, 10
  s_add_u32 s21, s21, s27
  s_add_u32 s21, s21, 0x1c0000
  s_lshl_b32 s28, s24, 7
  s_add_u32 s29, s28, 0x4d4000
  s_add_u32 s28, s28, 0x4d2000
  s_waitcnt lgkmcnt(0)
  s_and_b32 s9, s9, 0xffff
  s_and_b32 s13, s13, 0xffff
  v_lshlrev_b32 v11, 1, v2
  buffer_load_ushort v6, v11, s[12:15], s26 offen
  s_mul_i32 s23, s3, 7168
  s_add_u32 m0, s23, 0
  s_add_u32 s22, s20, 0
  buffer_load_dwordx4 v5, s[8:11], s22 offen lds
  s_add_u32 m0, s23, 1024
  s_add_u32 s22, s20, 57344
  buffer_load_dwordx4 v5, s[8:11], s22 offen lds
  s_add_u32 m0, s23, 2048
  s_add_u32 s22, s20, 114688
  buffer_load_dwordx4 v5, s[8:11], s22 offen lds
  s_add_u32 m0, s23, 3072
  s_add_u32 s22, s20, 172032
  buffer_load_dwordx4 v5, s[8:11], s22 offen lds
  s_add_u32 m0, s23, 4096
  s_add_u32 s22, s20, 229376
  buffer_load_dwordx4 v5, s[8:11], s22 offen lds
  s_add_u32 m0, s23, 5120
  s_add_u32 s22, s20, 286720
  buffer_load_dwordx4 v5, s[8:11], s22 offen lds
  s_add_u32 m0, s23, 6144
  s_add_u32 s22, s20, 344064
  buffer_load_dwordx4 v5, s[8:11], s22 offen lds
  v_add_u32 v7, s23, v7
  v_mov_b32 v12, 0
  v_mov_b32 v13, 0x3f803f80
  s_waitcnt vmcnt(6)
  ds_read_b64_tr_b16 v[16:17], v7 offset:0
  ds_read_b64_tr_b16 v[18:19], v7 offset:512
  s_waitcnt vmcnt(5)
  ds_read_b64_tr_b16 v[20:21], v7 offset:1024
  ds_read_b64_tr_b16 v[22:23], v7 offset:1536
  s_waitcnt vmcnt(4)
  ds_read_b64_tr_b16 v[24:25], v7 offset:2048
  ds_read_b64_tr_b16 v[26:27], v7 offset:2560
  s_waitcnt vmcnt(3)
  ds_read_b64_tr_b16 v[28:29], v7 offset:3072
  ds_read_b64_tr_b16 v[30:31], v7 offset:3584
  s_waitcnt vmcnt(2)
  ds_read_b64_tr_b16 v[32:33], v7 offset:4096
  ds_read_b64_tr_b16 v[34:35], v7 offset:4608
  s_waitcnt vmcnt(1)
  ds_read_b64_tr_b16 v[36:37], v7 offset:5120
  ds_read_b64_tr_b16 v[38:39], v7 offset:5632
  s_waitcnt vmcnt(0)
  ds_read_b64_tr_b16 v[40:41], v7 offset:6144
  ds_read_b64_tr_b16 v[42:43], v7 offset:6656
  s_waitcnt lgkmcnt(0)
  s_add_u32 s22, s21, 0
  buffer_store_dwordx4 v[16:19], v4, s[4:7], s22 offen sc1
  s_add_u32 s22, s21, 4096
  buffer_store_dwordx4 v[20:23], v4, s[4:7], s22 offen sc1
  s_add_u32 s22, s21, 8192
  buffer_store_dwordx4 v[24:27], v4, s[4:7], s22 offen sc1
  s_add_u32 s22, s21, 12288
  buffer_store_dwordx4 v[28:31], v4, s[4:7], s22 offen sc1
  s_add_u32 s22, s21, 16384
  buffer_store_dwordx4 v[32:35], v4, s[4:7], s22 offen sc1
  s_add_u32 s22, s21, 20480
  buffer_store_dwordx4 v[36:39], v4, s[4:7], s22 offen sc1
  s_add_u32 s22, s21, 24576
  buffer_store_dwordx4 v[40:43], v4, s[4:7], s22 offen sc1
  v_dot2_f32_bf16 v12, v16, v13, v12
  v_dot2_f32_bf16 v12, v17, v13, v12
  v_dot2_f32_bf16 v12, v18, v13, v12
  v_dot2_f32_bf16 v12, v19, v13, v12
  v_dot2_f32_bf16 v12, v20, v13, v12
  v_dot2_f32_bf16 v12, v21, v13, v12
  v_dot2_f32_bf16 v12, v22, v13, v12
  v_dot2_f32_bf16 v12, v23, v13, v12
  v_dot2_f32_bf16 v12, v24, v13, v12
  v_dot2_f32_bf16 v12, v25, v13, v12
  v_dot2_f32_bf16 v12, v26, v13, v12
  v_dot2_f32_bf16 v12, v27, v13, v12
  v_dot2_f32_bf16 v12, v28, v13, v12
  v_dot2_f32_bf16 v12, v29, v13, v12
  v_dot2_f32_bf16 v12, v30, v13, v12
  v_dot2_f32_bf16 v12, v31, v13, v12
  v_dot2_f32_bf16 v12, v32, v13, v12
  v_dot2_f32_bf16 v12, v33, v13, v12
  v_dot2_f32_bf16 v12, v34, v13, v12
  v_dot2_f32_bf16 v12, v35, v13, v12
  v_dot2_f32_bf16 v12, v36, v13, v12
  v_dot2_f32_bf16 v12, v37, v13, v12
  v_dot2_f32_bf16 v12, v38, v13, v12
  v_dot2_f32_bf16 v12, v39, v13, v12
  v_dot2_f32_bf16 v12, v40, v13, v12
  v_dot2_f32_bf16 v12, v41, v13, v12
  v_dot2_f32_bf16 v12, v42, v13, v12
  v_dot2_f32_bf16 v12, v43, v13, v12
  v_lshlrev_b32 v11, 2, v2
  v_lshlrev_b32 v6, 16, v6
  buffer_store_dword v6, v11, s[4:7], s29 offen sc1
  s_nop 3
  v_mov_b32 v14, v12
  s_nop 1
  v_permlane32_swap_b32 v12, v14
  s_nop 1
  v_add_f32 v12, v12, v14
  s_lshl_b32 s23, s3, 7
  s_add_u32 s23, s23, 28672
  v_lshlrev_b32 v11, 2, v2
  v_add_u32 v14, s23, v11
  ds_write_b32 v14, v12
  s_waitcnt lgkmcnt(0)
  s_barrier
  ds_read_b32 v12, v11 offset:28672
  ds_read_b32 v13, v11 offset:28800
  ds_read_b32 v14, v11 offset:28928
  ds_read_b32 v15, v11 offset:29056
  s_waitcnt lgkmcnt(0)
  v_add_f32 v12, v12, v13
  v_add_f32 v14, v14, v15
  v_add_f32 v12, v12, v14
  s_cmp_lg_u32 s3, 0
  s_cbranch_scc1 prep_1_done
  buffer_store_dword v12, v11, s[4:7], s28 offen sc1
prep_1_done:
  s_branch prep_done
prep_w2:
  s_mov_b32 s8, s48
  s_mov_b32 s9, s49
  s_mov_b32 s10, 1605632
  s_mov_b32 s11, 0x20000
  s_mov_b32 s12, s50
  s_mov_b32 s13, s51
  s_mov_b32 s14, 896
  s_mov_b32 s15, 0x20000
  s_sub_u32 s24, s2, 104
  s_lshr_b32 s25, s24, 2
  s_and_b32 s24, s24, 3
  s_mul_i32 s27, s24, 28
  s_mul_i32 s29, s3, 7
  s_add_u32 s27, s27, s29
  s_lshl_b32 s26, s25, 6
  s_mul_i32 s29, s27, 14336
  s_add_u32 s20, s26, s29
  v_mul_u32_u24 v5, 896, v8
  v_add_u32 v5, v5, v9
  s_mul_i32 s21, s25, 114688
  s_lshl_b32 s29, s27, 10
  s_add_u32 s21, s21, s29
  s_add_u32 s21, s21, 0x348000
  s_lshl_b32 s29, s25, 7
  s_add_u32 s29, s29, 0x4d6000
  s_waitcnt lgkmcnt(0)
  s_and_b32 s9, s9, 0xffff
  s_and_b32 s13, s13, 0xffff
  v_lshlrev_b32 v11, 1, v2
  buffer_load_ushort v6, v11, s[12:15], s26 offen
  s_mul_i32 s23, s3, 7168
  s_add_u32 m0, s23, 0
  s_add_u32 s22, s20, 0
  buffer_load_dwordx4 v5, s[8:11], s22 offen lds
  s_add_u32 m0, s23, 1024
  s_add_u32 s22, s20, 14336
  buffer_load_dwordx4 v5, s[8:11], s22 offen lds
  s_add_u32 m0, s23, 2048
  s_add_u32 s22, s20, 28672
  buffer_load_dwordx4 v5, s[8:11], s22 offen lds
  s_add_u32 m0, s23, 3072
  s_add_u32 s22, s20, 43008
  buffer_load_dwordx4 v5, s[8:11], s22 offen lds
  s_add_u32 m0, s23, 4096
  s_add_u32 s22, s20, 57344
  buffer_load_dwordx4 v5, s[8:11], s22 offen lds
  s_add_u32 m0, s23, 5120
  s_add_u32 s22, s20, 71680
  buffer_load_dwordx4 v5, s[8:11], s22 offen lds
  s_add_u32 m0, s23, 6144
  s_add_u32 s22, s20, 86016
  buffer_load_dwordx4 v5, s[8:11], s22 offen lds
  v_add_u32 v7, s23, v7
  s_waitcnt vmcnt(6)
  ds_read_b64_tr_b16 v[16:17], v7 offset:0
  ds_read_b64_tr_b16 v[18:19], v7 offset:512
  s_waitcnt vmcnt(5)
  ds_read_b64_tr_b16 v[20:21], v7 offset:1024
  ds_read_b64_tr_b16 v[22:23], v7 offset:1536
  s_waitcnt vmcnt(4)
  ds_read_b64_tr_b16 v[24:25], v7 offset:2048
  ds_read_b64_tr_b16 v[26:27], v7 offset:2560
  s_waitcnt vmcnt(3)
  ds_read_b64_tr_b16 v[28:29], v7 offset:3072
  ds_read_b64_tr_b16 v[30:31], v7 offset:3584
  s_waitcnt vmcnt(2)
  ds_read_b64_tr_b16 v[32:33], v7 offset:4096
  ds_read_b64_tr_b16 v[34:35], v7 offset:4608
  s_waitcnt vmcnt(1)
  ds_read_b64_tr_b16 v[36:37], v7 offset:5120
  ds_read_b64_tr_b16 v[38:39], v7 offset:5632
  s_waitcnt vmcnt(0)
  ds_read_b64_tr_b16 v[40:41], v7 offset:6144
  ds_read_b64_tr_b16 v[42:43], v7 offset:6656
  s_waitcnt lgkmcnt(0)
  s_add_u32 s22, s21, 0
  buffer_store_dwordx4 v[16:19], v4, s[4:7], s22 offen sc1
  s_add_u32 s22, s21, 1024
  buffer_store_dwordx4 v[20:23], v4, s[4:7], s22 offen sc1
  s_add_u32 s22, s21, 2048
  buffer_store_dwordx4 v[24:27], v4, s[4:7], s22 offen sc1
  s_add_u32 s22, s21, 3072
  buffer_store_dwordx4 v[28:31], v4, s[4:7], s22 offen sc1
  s_add_u32 s22, s21, 4096
  buffer_store_dwordx4 v[32:35], v4, s[4:7], s22 offen sc1
  s_add_u32 s22, s21, 5120
  buffer_store_dwordx4 v[36:39], v4, s[4:7], s22 offen sc1
  s_add_u32 s22, s21, 6144
  buffer_store_dwordx4 v[40:43], v4, s[4:7], s22 offen sc1
  v_lshlrev_b32 v11, 2, v2
  v_lshlrev_b32 v6, 16, v6
  buffer_store_dword v6, v11, s[4:7], s29 offen sc1
  s_branch prep_done
prep_wo:
  s_mov_b32 s8, s40
  s_mov_b32 s9, s41
  s_mov_b32 s10, 401408
  s_mov_b32 s11, 0x20000
  s_sub_u32 s24, s2, 160
  s_lshr_b32 s25, s24, 1
  s_and_b32 s24, s24, 1
  s_lshl_b32 s27, s24, 4
  s_lshl_b32 s29, s3, 2
  s_add_u32 s27, s27, s29
  s_mul_i32 s29, s27, 12544
  s_lshl_b32 s26, s25, 6
  s_add_u32 s20, s26, s29
  v_mul_u32_u24 v5, 896, v8
  v_add_u32 v5, v5, v9
  v_mov_b32 v10, 0x7f000000
  v_cmp_gt_u32 vcc, 12, v8
  s_nop 1
  v_cndmask_b32 v6, v10, v5, vcc
  s_mul_i32 s21, s25, 32768
  s_lshl_b32 s29, s27, 10
  s_add_u32 s21, s21, s29
  s_add_u32 s21, s21, 0x150000
  s_waitcnt lgkmcnt(0)
  s_and_b32 s9, s9, 0xffff
  s_mul_i32 s23, s3, 4096
  s_add_u32 m0, s23, 0
  s_add_u32 s22, s20, 0
  buffer_load_dwordx4 v5, s[8:11], s22 offen lds
  s_add_u32 m0, s23, 1024
  s_add_u32 s22, s20, 14336
  buffer_load_dwordx4 v6, s[8:11], s22 offen lds
  s_add_u32 m0, s23, 2048
  s_add_u32 s22, s20, 25088
  buffer_load_dwordx4 v5, s[8:11], s22 offen lds
  s_add_u32 m0, s23, 3072
  s_add_u32 s22, s20, 39424
  buffer_load_dwordx4 v6, s[8:11], s22 offen lds
  v_add_u32 v7, s23, v7
  s_waitcnt vmcnt(3)
  ds_read_b64_tr_b16 v[16:17], v7 offset:0
  ds_read_b64_tr_b16 v[18:19], v7 offset:512
  s_waitcnt vmcnt(2)
  ds_read_b64_tr_b16 v[20:21], v7 offset:1024
  ds_read_b64_tr_b16 v[22:23], v7 offset:1536
  s_waitcnt vmcnt(1)
  ds_read_b64_tr_b16 v[24:25], v7 offset:2048
  ds_read_b64_tr_b16 v[26:27], v7 offset:2560
  s_waitcnt vmcnt(0)
  ds_read_b64_tr_b16 v[28:29], v7 offset:3072
  ds_read_b64_tr_b16 v[30:31], v7 offset:3584
  s_waitcnt lgkmcnt(0)
  s_add_u32 s22, s21, 0
  buffer_store_dwordx4 v[16:19], v4, s[4:7], s22 offen sc1
  s_add_u32 s22, s21, 1024
  buffer_store_dwordx4 v[20:23], v4, s[4:7], s22 offen sc1
  s_add_u32 s22, s21, 2048
  buffer_store_dwordx4 v[24:27], v4, s[4:7], s22 offen sc1
  s_add_u32 s22, s21, 3072
  buffer_store_dwordx4 v[28:31], v4, s[4:7], s22 offen sc1
  s_branch prep_done
prep_x:
  s_mov_b32 s8, s36
  s_mov_b32 s9, s37
  s_mov_b32 s10, 1835008
  s_mov_b32 s11, 0x20000
  s_sub_u32 s24, s2, 188
  v_mul_u32_u24 v5, 896, v2
  v_lshl_add_u32 v5, v3, 3, v5
  s_mul_i32 s20, s24, 28672
  s_mul_i32 s27, s3, 224
  s_add_u32 s20, s20, s27
  s_mul_i32 s21, s24, 28672
  s_mul_i32 s27, s3, 7168
  s_add_u32 s21, s21, s27
  s_add_u32 s21, s21, 0x600000
  s_waitcnt lgkmcnt(0)
  s_and_b32 s9, s9, 0xffff
  buffer_load_dwordx2 v[16:17], v5, s[8:11], s20 offen offset:0
  buffer_load_dwordx2 v[18:19], v5, s[8:11], s20 offen offset:16
  buffer_load_dwordx2 v[20:21], v5, s[8:11], s20 offen offset:32
  buffer_load_dwordx2 v[22:23], v5, s[8:11], s20 offen offset:48
  buffer_load_dwordx2 v[24:25], v5, s[8:11], s20 offen offset:64
  buffer_load_dwordx2 v[26:27], v5, s[8:11], s20 offen offset:80
  buffer_load_dwordx2 v[28:29], v5, s[8:11], s20 offen offset:96
  buffer_load_dwordx2 v[30:31], v5, s[8:11], s20 offen offset:112
  buffer_load_dwordx2 v[32:33], v5, s[8:11], s20 offen offset:128
  buffer_load_dwordx2 v[34:35], v5, s[8:11], s20 offen offset:144
  buffer_load_dwordx2 v[36:37], v5, s[8:11], s20 offen offset:160
  buffer_load_dwordx2 v[38:39], v5, s[8:11], s20 offen offset:176
  buffer_load_dwordx2 v[40:41], v5, s[8:11], s20 offen offset:192
  buffer_load_dwordx2 v[42:43], v5, s[8:11], s20 offen offset:208
  v_mov_b32 v8, 0
  v_mov_b32 v9, 0
  v_mov_b32 v10, 0x3f803f80
  s_waitcnt vmcnt(0)
  s_add_u32 s22, s21, 0
  buffer_store_dwordx4 v[16:19], v4, s[4:7], s22 offen sc1
  s_add_u32 s22, s21, 1024
  buffer_store_dwordx4 v[20:23], v4, s[4:7], s22 offen sc1
  s_add_u32 s22, s21, 2048
  buffer_store_dwordx4 v[24:27], v4, s[4:7], s22 offen sc1
  s_add_u32 s22, s21, 3072
  buffer_store_dwordx4 v[28:31], v4, s[4:7], s22 offen sc1
  s_add_u32 s22, s21, 4096
  buffer_store_dwordx4 v[32:35], v4, s[4:7], s22 offen sc1
  s_add_u32 s22, s21, 5120
  buffer_store_dwordx4 v[36:39], v4, s[4:7], s22 offen sc1
  s_add_u32 s22, s21, 6144
  buffer_store_dwordx4 v[40:43], v4, s[4:7], s22 offen sc1
  v_dot2_f32_bf16 v8, v16, v10, v8
  v_dot2_f32_bf16 v9, v16, v16, v9
  v_dot2_f32_bf16 v8, v17, v10, v8
  v_dot2_f32_bf16 v9, v17, v17, v9
  v_dot2_f32_bf16 v8, v18, v10, v8
  v_dot2_f32_bf16 v9, v18, v18, v9
  v_dot2_f32_bf16 v8, v19, v10, v8
  v_dot2_f32_bf16 v9, v19, v19, v9
  v_dot2_f32_bf16 v8, v20, v10, v8
  v_dot2_f32_bf16 v9, v20, v20, v9
  v_dot2_f32_bf16 v8, v21, v10, v8
  v_dot2_f32_bf16 v9, v21, v21, v9
  v_dot2_f32_bf16 v8, v22, v10, v8
  v_dot2_f32_bf16 v9, v22, v22, v9
  v_dot2_f32_bf16 v8, v23, v10, v8
  v_dot2_f32_bf16 v9, v23, v23, v9
  v_dot2_f32_bf16 v8, v24, v10, v8
  v_dot2_f32_bf16 v9, v24, v24, v9
  v_dot2_f32_bf16 v8, v25, v10, v8
  v_dot2_f32_bf16 v9, v25, v25, v9
  v_dot2_f32_bf16 v8, v26, v10, v8
  v_dot2_f32_bf16 v9, v26, v26, v9
  v_dot2_f32_bf16 v8, v27, v10, v8
  v_dot2_f32_bf16 v9, v27, v27, v9
  v_dot2_f32_bf16 v8, v28, v10, v8
  v_dot2_f32_bf16 v9, v28, v28, v9
  v_dot2_f32_bf16 v8, v29, v10, v8
  v_dot2_f32_bf16 v9, v29, v29, v9
  v_dot2_f32_bf16 v8, v30, v10, v8
  v_dot2_f32_bf16 v9, v30, v30, v9
  v_dot2_f32_bf16 v8, v31, v10, v8
  v_dot2_f32_bf16 v9, v31, v31, v9
  v_dot2_f32_bf16 v8, v32, v10, v8
  v_dot2_f32_bf16 v9, v32, v32, v9
  v_dot2_f32_bf16 v8, v33, v10, v8
  v_dot2_f32_bf16 v9, v33, v33, v9
  v_dot2_f32_bf16 v8, v34, v10, v8
  v_dot2_f32_bf16 v9, v34, v34, v9
  v_dot2_f32_bf16 v8, v35, v10, v8
  v_dot2_f32_bf16 v9, v35, v35, v9
  v_dot2_f32_bf16 v8, v36, v10, v8
  v_dot2_f32_bf16 v9, v36, v36, v9
  v_dot2_f32_bf16 v8, v37, v10, v8
  v_dot2_f32_bf16 v9, v37, v37, v9
  v_dot2_f32_bf16 v8, v38, v10, v8
  v_dot2_f32_bf16 v9, v38, v38, v9
  v_dot2_f32_bf16 v8, v39, v10, v8
  v_dot2_f32_bf16 v9, v39, v39, v9
  v_dot2_f32_bf16 v8, v40, v10, v8
  v_dot2_f32_bf16 v9, v40, v40, v9
  v_dot2_f32_bf16 v8, v41, v10, v8
  v_dot2_f32_bf16 v9, v41, v41, v9
  v_dot2_f32_bf16 v8, v42, v10, v8
  v_dot2_f32_bf16 v9, v42, v42, v9
  v_dot2_f32_bf16 v8, v43, v10, v8
  v_dot2_f32_bf16 v9, v43, v43, v9
  s_nop 3
  v_mov_b32 v12, v8
  v_mov_b32 v13, v9
  s_nop 1
  v_permlane32_swap_b32 v8, v12
  v_permlane32_swap_b32 v9, v13
  s_nop 1
  v_add_f32 v8, v8, v12
  v_add_f32 v9, v9, v13
  v_cmp_eq_u32 vcc, 0, v3
  s_nop 1
  v_cndmask_b32 v8, 0, v8, vcc
  v_cndmask_b32 v9, 0, v9, vcc
  v_lshlrev_b32 v11, 3, v2
  v_lshl_add_u32 v11, v3, 16, v11
  s_lshl_b32 s22, s24, 8
  s_lshl_b32 s27, s3, 14
  s_add_u32 s22, s22, s27
  s_add_u32 s22, s22, 0x500000
  buffer_store_dwordx2 v[8:9], v11, s[4:7], s22 offen sc1
  v_mov_b32 v14, 0
  v_mov_b32 v15, 0
  s_add_u32 s22, s22, 0x20000
  buffer_store_dwordx2 v[14:15], v11, s[4:7], s22 offen sc1
  s_branch prep_done
prep_done:
  v_mov_b32 v7, 0
  s_cmp_lg_u32 s3, 0
  s_cbranch_scc1 g0_w
  buffer_load_dword v6, v7, s[52:55], 0 offen sc0 sc1
g0_w:
  s_waitcnt vmcnt(0)
  s_barrier
  s_cmp_lg_u32 s3, 0
  s_cbranch_scc1 g0_end
  s_mov_b32 s42, 0
g0_nonce:
  v_readfirstlane_b32 s67, v6
  s_cmp_lg_u32 s67, 0
  s_cbranch_scc1 g0_have
  s_add_u32 s42, s42, 1
  s_cmp_gt_u32 s42, 0x40000
  s_cbranch_scc1 g0_have
  buffer_load_dword v6, v7, s[52:55], 0 offen sc0 sc1
  s_waitcnt vmcnt(0)
  s_branch g0_nonce
g0_have:
  s_and_b32 s67, s67, -16
  s_add_u32 s68, s67, 12
  s_getreg_b32 s30, hwreg(HW_REG_XCC_ID)
  s_and_b32 s30, s30, 7
  s_or_b32 s30, s30, s67
  s_and_b32 s31, s2, 7
  s_lshl_b32 s31, s31, 7
  s_lshr_b32 s32, s2, 3
  s_lshl_b32 s33, s32, 2
  s_add_u32 s31, s31, s33
  s_add_u32 s31, s31, 0x4e0000
  s_lshl_b32 s33, s2, 6
  s_add_u32 s33, s33, 0x4e4000
  v_mov_b32 v6, s68
  v_mov_b32 v8, s30
  s_mov_b64 exec, 1
  buffer_store_dword v6, v7, s[4:7], s33 offen sc0 sc1
  buffer_store_dword v8, v7, s[4:7], s31 offen sc0 sc1
  s_mov_b64 exec, -1
  s_lshr_b32 s30, s32, 1
  s_mul_i32 s30, s30, 3
  s_and_b32 s31, s2, 7
  s_lshl_b32 s31, s31, 1
  s_and_b32 s33, s32, 1
  s_add_u32 s31, s31, s33
  s_lshl_b32 s31, s31, 2
  s_add_u32 s31, s31, 185
  v_add_u32 v8, s30, v0
  v_add_u32 v9, s31, v0
  v_cmp_gt_u32 vcc, 3, v0
  s_nop 1
  v_cndmask_b32 v8, v9, v8, vcc
  v_lshlrev_b32 v8, 6, v8
  v_add_u32 v8, 0x4e4000, v8
  s_mov_b64 exec, 0x7f
  s_mov_b32 s42, 0
dp_1:
  s_add_u32 s42, s42, 1
  s_cmp_gt_u32 s42, 0x40000
  s_cbranch_scc1 dpd_2
  buffer_load_dword v9, v8, s[4:7], 0 offen sc0 sc1
  s_waitcnt vmcnt(0)
  v_cmp_ne_u32 vcc, s68, v9
  s_cbranch_vccnz dp_1
dpd_2:
  s_mov_b64 exec, -1
g0_end:
  s_barrier
  s_load_dwordx2 s[8:9], s[0:1], 64
  s_mov_b32 s10, 1835008
  s_mov_b32 s11, 0x20000
  v_and_b32 v2, 31, v0
  v_lshrrev_b32 v3, 5, v0
  v_lshlrev_b32 v4, 4, v0
  s_and_b32 s12, s2, 7
  s_lshr_b32 s13, s2, 3
  s_mov_b32 s14, 0
  s_mov_b32 s15, 0
  s_mov_b32 s16, 0
  s_getreg_b32 s30, hwreg(HW_REG_XCC_ID)
  s_and_b32 s26, s13, 1
  s_lshl_b32 s27, s12, 1
  s_add_u32 s26, s26, s27
  s_lshl_b32 s26, s26, 2
  s_add_u32 s26, s26, s3
  s_lshr_b32 s27, s13, 1
  s_and_b32 s28, s13, 3
  s_lshl_b32 s29, s12, 2
  s_add_u32 s28, s28, s29
  s_lshr_b32 s29, s13, 2
  s_lshr_b32 s32, s3, 1
  s_lshl_b32 s35, s28, 1
  s_add_u32 s35, s35, s32
  s_and_b32 s32, s3, 1
  s_lshl_b32 s36, s29, 1
  s_add_u32 s36, s36, s32
  s_mul_i32 s37, s35, 28
  s_lshl_b32 s32, s36, 1
  s_add_u32 s37, s37, s32
  s_lshl_b32 s37, s37, 10
  s_waitcnt lgkmcnt(0)
  s_and_b32 s5, s5, 0xffff
  s_and_b32 s9, s9, 0xffff
  s_lshr_b32 s44, s13, 1
  s_mul_i32 s44, s44, 86016
  s_mul_i32 s45, s3, 3072
  s_add_u32 s44, s44, s45
  s_add_u32 s44, s44, 0x0
  s_mov_b32 m0, s45
  s_add_u32 s45, s45, 12288
  buffer_load_dwordx4 v4, s[4:7], s44 offen offset:0 lds
  buffer_load_dwordx4 v4, s[4:7], s44 offen offset:1024 lds
  buffer_load_dwordx4 v4, s[4:7], s44 offen offset:2048 lds
  s_add_u32 s44, s44, 12288
  s_mov_b32 m0, s45
  s_add_u32 s45, s45, 12288
  buffer_load_dwordx4 v4, s[4:7], s44 offen offset:0 lds
  buffer_load_dwordx4 v4, s[4:7], s44 offen offset:1024 lds
  buffer_load_dwordx4 v4, s[4:7], s44 offen offset:2048 lds
  s_add_u32 s44, s44, 12288
  s_mov_b32 m0, s45
  s_add_u32 s45, s45, 12288
  buffer_load_dwordx4 v4, s[4:7], s44 offen offset:0 lds
  buffer_load_dwordx4 v4, s[4:7], s44 offen offset:1024 lds
  buffer_load_dwordx4 v4, s[4:7], s44 offen offset:2048 lds
  s_add_u32 s44, s44, 12288
  s_mov_b32 m0, s45
  s_add_u32 s45, s45, 12288
  buffer_load_dwordx4 v4, s[4:7], s44 offen offset:0 lds
  buffer_load_dwordx4 v4, s[4:7], s44 offen offset:1024 lds
  buffer_load_dwordx4 v4, s[4:7], s44 offen offset:2048 lds
  s_add_u32 s44, s44, 12288
  s_mov_b32 m0, s45
  s_add_u32 s45, s45, 12288
  buffer_load_dwordx4 v4, s[4:7], s44 offen offset:0 lds
  buffer_load_dwordx4 v4, s[4:7], s44 offen offset:1024 lds
  buffer_load_dwordx4 v4, s[4:7], s44 offen offset:2048 lds
  s_add_u32 s44, s44, 12288
  s_mov_b32 m0, s45
  s_add_u32 s45, s45, 12288
  buffer_load_dwordx4 v4, s[4:7], s44 offen offset:0 lds
  buffer_load_dwordx4 v4, s[4:7], s44 offen offset:1024 lds
  buffer_load_dwordx4 v4, s[4:7], s44 offen offset:2048 lds
  s_add_u32 s44, s44, 12288
  s_mov_b32 m0, s45
  s_add_u32 s45, s45, 12288
  buffer_load_dwordx4 v4, s[4:7], s44 offen offset:0 lds
  buffer_load_dwordx4 v4, s[4:7], s44 offen offset:1024 lds
  buffer_load_dwordx4 v4, s[4:7], s44 offen offset:2048 lds
  s_add_u32 s44, s44, 12288
  s_lshl_b32 s31, s12, 7
  s_add_u32 s31, s31, 0x4e1000
  v_mov_b32 v7, 0
  buffer_load_dword v1, v7, s[4:7], s31 offen sc1
layer_loop:
  s_lshl_b32 s30, s14, 1
  s_mul_i32 s17, s30, 0x1c0000
  s_add_u32 s17, s17, 0x600000
  s_add_u32 s21, s17, 0x1c0000
  s_add_u32 s24, s21, 0x1c0000
  s_mul_i32 s18, s30, 0x40000
  s_add_u32 s18, s18, 0x500000
  s_add_u32 s22, s18, 0x40000
  s_add_u32 s25, s22, 0x40000
  s_lshl_b32 s19, s14, 22
  s_add_u32 s19, s19, 0xd00000
  s_mov_b32 s20, 0x1500000
  s_mov_b32 s23, 0x1900000
  s_mov_b32 s21, 0x7c0000
  s_mov_b32 s22, 0x540000
  v_lshlrev_b32 v6, 4, v3
  s_mul_i32 s30, s26, 28672
  s_add_u32 s30, s30, s17
  buffer_load_dwordx4 a[0:3], v4, s[4:7], s30 offen offset:0
  buffer_load_dwordx4 a[4:7], v4, s[4:7], s30 offen offset:1024
  buffer_load_dwordx4 a[8:11], v4, s[4:7], s30 offen offset:2048
  buffer_load_dwordx4 a[12:15], v4, s[4:7], s30 offen offset:3072
  s_add_u32 s30, s30, 4096
  v_mul_u32_u24 v5, 114688, v3
  v_lshl_add_u32 v5, v2, 3, v5
  s_lshl_b32 s31, s26, 8
  s_add_u32 s31, s31, s18
  buffer_load_dwordx2 v[176:177], v5, s[4:7], s31 offen sc1
  s_add_u32 s31, s31, 16384
  buffer_load_dwordx2 v[178:179], v5, s[4:7], s31 offen sc1
  s_add_u32 s31, s31, 16384
  buffer_load_dwordx2 v[180:181], v5, s[4:7], s31 offen sc1
  s_add_u32 s31, s31, 16384
  buffer_load_dwordx2 v[182:183], v5, s[4:7], s31 offen sc1
  s_add_u32 s31, s31, 16384
  buffer_load_dwordx2 v[184:185], v5, s[4:7], s31 offen sc1
  s_add_u32 s31, s31, 16384
  buffer_load_dwordx2 v[186:187], v5, s[4:7], s31 offen sc1
  s_add_u32 s31, s31, 16384
  buffer_load_dwordx2 v[188:189], v5, s[4:7], s31 offen sc1
  buffer_load_dwordx4 a[16:19], v4, s[4:7], s30 offen offset:0
  buffer_load_dwordx4 a[20:23], v4, s[4:7], s30 offen offset:1024
  buffer_load_dwordx4 a[24:27], v4, s[4:7], s30 offen offset:2048
  buffer_load_dwordx4 a[28:31], v4, s[4:7], s30 offen offset:3072
  s_add_u32 s30, s30, 4096
  s_mul_i32 s31, s27, 384
  s_add_u32 s31, s31, 0x4d0000
  s_lshl_b32 s33, s3, 10
  s_add_u32 s33, s33, 118784
  s_mov_b32 m0, s33
  s_nop 0
  buffer_load_dwordx4 v4, s[4:7], s31 offen lds
  v_add_u32 v8, 0x10000, v4
  s_waitcnt vmcnt(15)
  s_barrier
  ds_read_b128 a[112:115], v4 offset:1024
  ds_read_b128 a[116:119], v4 offset:2048
  ds_read_b128 a[120:123], v4 offset:4096
  ds_read_b128 a[124:127], v4 offset:5120
  ds_read_b128 a[128:131], v4 offset:7168
  ds_read_b128 a[132:135], v4 offset:8192
  ds_read_b128 a[136:139], v4 offset:10240
  ds_read_b128 a[140:143], v4 offset:11264
  s_waitcnt vmcnt(15)
  s_waitcnt lgkmcnt(6)
  v_mfma_f32_32x32x16_bf16 v[16:31], a[112:115], a[0:3], 0
  ds_read_b128 a[144:147], v4 offset:13312
  buffer_load_dwordx4 a[32:35], v4, s[4:7], s30 offen offset:0
  v_mfma_f32_32x32x16_bf16 v[32:47], a[0:3], a[116:119], 0
  ds_read_b128 a[148:151], v4 offset:14336
  s_waitcnt vmcnt(15)
  s_waitcnt lgkmcnt(6)
  v_mfma_f32_32x32x16_bf16 v[16:31], a[120:123], a[4:7], v[16:31]
  ds_read_b128 a[152:155], v4 offset:16384
  buffer_load_dwordx4 a[36:39], v4, s[4:7], s30 offen offset:1024
  v_mfma_f32_32x32x16_bf16 v[32:47], a[4:7], a[124:127], v[32:47]
  ds_read_b128 a[156:159], v4 offset:17408
  s_waitcnt vmcnt(15)
  s_waitcnt lgkmcnt(6)
  v_mfma_f32_32x32x16_bf16 v[16:31], a[128:131], a[8:11], v[16:31]
  ds_read_b128 a[112:115], v4 offset:19456
  buffer_load_dwordx4 a[40:43], v4, s[4:7], s30 offen offset:2048
  v_mfma_f32_32x32x16_bf16 v[32:47], a[8:11], a[132:135], v[32:47]
  ds_read_b128 a[116:119], v4 offset:20480
  s_waitcnt vmcnt(15)
  s_waitcnt lgkmcnt(6)
  v_mfma_f32_32x32x16_bf16 v[16:31], a[136:139], a[12:15], v[16:31]
  ds_read_b128 a[120:123], v4 offset:22528
  buffer_load_dwordx4 a[44:47], v4, s[4:7], s30 offen offset:3072
  s_add_u32 s30, s30, 4096
  v_mfma_f32_32x32x16_bf16 v[32:47], a[12:15], a[140:143], v[32:47]
  ds_read_b128 a[124:127], v4 offset:23552
  s_waitcnt vmcnt(8)
  s_waitcnt lgkmcnt(6)
  v_mfma_f32_32x32x16_bf16 v[16:31], a[144:147], a[16:19], v[16:31]
  ds_read_b128 a[128:131], v4 offset:25600
  buffer_load_dwordx4 a[48:51], v4, s[4:7], s30 offen offset:0
  v_mfma_f32_32x32x16_bf16 v[32:47], a[16:19], a[148:151], v[32:47]
  ds_read_b128 a[132:135], v4 offset:26624
  s_waitcnt vmcnt(10)
  v_add_f32 v176, v176, v178
  v_add_f32 v177, v177, v179
  s_waitcnt vmcnt(8)
  s_waitcnt lgkmcnt(6)
  v_mfma_f32_32x32x16_bf16 v[16:31], a[152:155], a[20:23], v[16:31]
  ds_read_b128 a[136:139], v4 offset:28672
  buffer_load_dwordx4 a[52:55], v4, s[4:7], s30 offen offset:1024
  v_mfma_f32_32x32x16_bf16 v[32:47], a[20:23], a[156:159], v[32:47]
  ds_read_b128 a[140:143], v4 offset:29696
  v_add_f32 v176, v176, v180
  v_add_f32 v177, v177, v181
  s_waitcnt vmcnt(8)
  s_waitcnt lgkmcnt(6)
  v_mfma_f32_32x32x16_bf16 v[16:31], a[112:115], a[24:27], v[16:31]
  ds_read_b128 a[144:147], v4 offset:31744
  buffer_load_dwordx4 a[56:59], v4, s[4:7], s30 offen offset:2048
  v_mfma_f32_32x32x16_bf16 v[32:47], a[24:27], a[116:119], v[32:47]
  ds_read_b128 a[148:151], v4 offset:32768
  v_add_f32 v176, v176, v182
  v_add_f32 v177, v177, v183
  s_waitcnt vmcnt(8)
  s_waitcnt lgkmcnt(6)
  v_mfma_f32_32x32x16_bf16 v[16:31], a[120:123], a[28:31], v[16:31]
  ds_read_b128 a[152:155], v4 offset:34816
  buffer_load_dwordx4 a[60:63], v4, s[4:7], s30 offen offset:3072
  s_add_u32 s30, s30, 4096
  v_mfma_f32_32x32x16_bf16 v[32:47], a[28:31], a[124:127], v[32:47]
  ds_read_b128 a[156:159], v4 offset:35840
  v_add_f32 v176, v176, v184
  v_add_f32 v177, v177, v185
  s_waitcnt vmcnt(7)
  s_waitcnt lgkmcnt(6)
  v_mfma_f32_32x32x16_bf16 v[16:31], a[128:131], a[32:35], v[16:31]
  ds_read_b128 a[112:115], v4 offset:37888
  buffer_load_dwordx4 a[64:67], v4, s[4:7], s30 offen offset:0
  v_mfma_f32_32x32x16_bf16 v[32:47], a[32:35], a[132:135], v[32:47]
  ds_read_b128 a[116:119], v4 offset:38912
  v_add_f32 v176, v176, v186
  v_add_f32 v177, v177, v187
  s_waitcnt vmcnt(7)
  s_waitcnt lgkmcnt(6)
  v_mfma_f32_32x32x16_bf16 v[16:31], a[136:139], a[36:39], v[16:31]
  ds_read_b128 a[120:123], v4 offset:40960
  buffer_load_dwordx4 a[68:71], v4, s[4:7], s30 offen offset:1024
  v_mfma_f32_32x32x16_bf16 v[32:47], a[36:39], a[140:143], v[32:47]
  ds_read_b128 a[124:127], v4 offset:41984
  v_add_f32 v176, v176, v188
  v_add_f32 v177, v177, v189
  s_waitcnt vmcnt(7)
  s_waitcnt lgkmcnt(6)
  v_mfma_f32_32x32x16_bf16 v[16:31], a[144:147], a[40:43], v[16:31]
  ds_read_b128 a[128:131], v4 offset:44032
  buffer_load_dwordx4 a[72:75], v4, s[4:7], s30 offen offset:2048
  v_mfma_f32_32x32x16_bf16 v[32:47], a[40:43], a[148:151], v[32:47]
  ds_read_b128 a[132:135], v4 offset:45056
  v_mov_b32 v14, v176
  v_mov_b32 v15, v177
  s_waitcnt vmcnt(7)
  s_waitcnt lgkmcnt(6)
  v_mfma_f32_32x32x16_bf16 v[16:31], a[152:155], a[44:47], v[16:31]
  ds_read_b128 a[136:139], v4 offset:47104
  buffer_load_dwordx4 a[76:79], v4, s[4:7], s30 offen offset:3072
  s_add_u32 s30, s30, 4096
  v_mfma_f32_32x32x16_bf16 v[32:47], a[44:47], a[156:159], v[32:47]
  ds_read_b128 a[140:143], v4 offset:48128
  s_nop 1
  v_permlane32_swap_b32 v176, v14
  s_waitcnt vmcnt(7)
  s_waitcnt lgkmcnt(6)
  v_mfma_f32_32x32x16_bf16 v[16:31], a[112:115], a[48:51], v[16:31]
  ds_read_b128 a[144:147], v4 offset:50176
  buffer_load_dwordx4 a[80:83], v4, s[4:7], s30 offen offset:0
  v_mfma_f32_32x32x16_bf16 v[32:47], a[48:51], a[116:119], v[32:47]
  ds_read_b128 a[148:151], v4 offset:51200
  v_permlane32_swap_b32 v177, v15
  s_nop 1
  s_waitcnt vmcnt(7)
  s_waitcnt lgkmcnt(6)
  v_mfma_f32_32x32x16_bf16 v[16:31], a[120:123], a[52:55], v[16:31]
  ds_read_b128 a[152:155], v4 offset:53248
  buffer_load_dwordx4 a[84:87], v4, s[4:7], s30 offen offset:1024
  v_mfma_f32_32x32x16_bf16 v[32:47], a[52:55], a[124:127], v[32:47]
  ds_read_b128 a[156:159], v4 offset:54272
  v_add_f32 v176, v176, v14
  v_add_f32 v177, v177, v15
  s_waitcnt vmcnt(7)
  s_waitcnt lgkmcnt(6)
  v_mfma_f32_32x32x16_bf16 v[16:31], a[128:131], a[56:59], v[16:31]
  ds_read_b128 a[112:115], v4 offset:56320
  buffer_load_dwordx4 a[88:91], v4, s[4:7], s30 offen offset:2048
  v_mfma_f32_32x32x16_bf16 v[32:47], a[56:59], a[132:135], v[32:47]
  ds_read_b128 a[116:119], v4 offset:57344
  v_mul_f32 v10, 0xbb124925, v176
  v_mul_f32 v14, 0x3b124925, v177
  s_waitcnt vmcnt(7)
  s_waitcnt lgkmcnt(6)
  v_mfma_f32_32x32x16_bf16 v[16:31], a[136:139], a[60:63], v[16:31]
  ds_read_b128 a[120:123], v4 offset:59392
  buffer_load_dwordx4 a[92:95], v4, s[4:7], s30 offen offset:3072
  s_add_u32 s30, s30, 4096
  v_mfma_f32_32x32x16_bf16 v[32:47], a[60:63], a[140:143], v[32:47]
  ds_read_b128 a[124:127], v4 offset:60416
  v_fma_f32 v14, -v10, v10, v14
  v_max_f32 v14, 0, v14
  s_waitcnt vmcnt(7)
  s_waitcnt lgkmcnt(6)
  v_mfma_f32_32x32x16_bf16 v[16:31], a[144:147], a[64:67], v[16:31]
  ds_read_b128 a[128:131], v4 offset:62464
  buffer_load_dwordx4 a[96:99], v4, s[4:7], s30 offen offset:0
  v_mfma_f32_32x32x16_bf16 v[32:47], a[64:67], a[148:151], v[32:47]
  ds_read_b128 a[132:135], v4 offset:63488
  v_add_f32 v14, 0x3727c5ac, v14
  v_rsq_f32 v12, v14
  s_waitcnt vmcnt(7)
  s_waitcnt lgkmcnt(6)
  v_mfma_f32_32x32x16_bf16 v[16:31], a[152:155], a[68:71], v[16:31]
  ds_read_b128 a[136:139], v8 offset:0
  buffer_load_dwordx4 a[100:103], v4, s[4:7], s30 offen offset:1024
  v_mfma_f32_32x32x16_bf16 v[32:47], a[68:71], a[156:159], v[32:47]
  ds_read_b128 a[140:143], v8 offset:1024
  s_nop 0
  v_mul_f32 v15, v10, v12
  s_waitcnt vmcnt(7)
  s_waitcnt lgkmcnt(6)
  v_mfma_f32_32x32x16_bf16 v[16:31], a[112:115], a[72:75], v[16:31]
  ds_read_b128 a[144:147], v8 offset:3072
  buffer_load_dwordx4 a[104:107], v4, s[4:7], s30 offen offset:2048
  v_mfma_f32_32x32x16_bf16 v[32:47], a[72:75], a[116:119], v[32:47]
  ds_read_b128 a[148:151], v8 offset:4096
  v_mul_f32 v14, 0x3e8b97f6, v12
  v_cmp_eq_u32 vcc, 28, v2
  s_waitcnt vmcnt(7)
  s_waitcnt lgkmcnt(6)
  v_mfma_f32_32x32x16_bf16 v[16:31], a[120:123], a[76:79], v[16:31]
  ds_read_b128 a[152:155], v8 offset:6144
  buffer_load_dwordx4 a[108:111], v4, s[4:7], s30 offen offset:3072
  v_mfma_f32_32x32x16_bf16 v[32:47], a[76:79], a[124:127], v[32:47]
  ds_read_b128 a[156:159], v8 offset:7168
  v_mov_b32 v9, 1.0
  s_lshl_b32 s32, s3, 8
  s_waitcnt vmcnt(7)
  s_waitcnt lgkmcnt(6)
  v_mfma_f32_32x32x16_bf16 v[16:31], a[128:131], a[80:83], v[16:31]
  ds_read_b128 a[112:115], v8 offset:9216
  v_mfma_f32_32x32x16_bf16 v[32:47], a[80:83], a[132:135], v[32:47]
  ds_read_b128 a[116:119], v8 offset:10240
  v_cndmask_b32 v9, 0, v9, vcc
  s_add_u32 s32, s32, 114688
  s_waitcnt vmcnt(6)
  s_waitcnt lgkmcnt(6)
  v_mfma_f32_32x32x16_bf16 v[16:31], a[136:139], a[84:87], v[16:31]
  ds_read_b128 a[120:123], v8 offset:12288
  v_mfma_f32_32x32x16_bf16 v[32:47], a[84:87], a[140:143], v[32:47]
  ds_read_b128 a[124:127], v8 offset:13312
  v_lshlrev_b32 v7, 2, v2
  v_add_u32 v7, s32, v7
  s_waitcnt vmcnt(5)
  s_waitcnt lgkmcnt(6)
  v_mfma_f32_32x32x16_bf16 v[16:31], a[144:147], a[88:91], v[16:31]
  ds_read_b128 a[128:131], v8 offset:15360
  v_mfma_f32_32x32x16_bf16 v[32:47], a[88:91], a[148:151], v[32:47]
  ds_read_b128 a[132:135], v8 offset:16384
  s_waitcnt vmcnt(4)
  s_waitcnt lgkmcnt(6)
  v_mfma_f32_32x32x16_bf16 v[16:31], a[152:155], a[92:95], v[16:31]
  ds_read_b128 a[136:139], v8 offset:18432
  v_mfma_f32_32x32x16_bf16 v[32:47], a[92:95], a[156:159], v[32:47]
  ds_read_b128 a[140:143], v8 offset:19456
  s_waitcnt vmcnt(3)
  s_waitcnt lgkmcnt(6)
  v_mfma_f32_32x32x16_bf16 v[16:31], a[112:115], a[96:99], v[16:31]
  v_mfma_f32_32x32x16_bf16 v[32:47], a[96:99], a[116:119], v[32:47]
  s_waitcnt vmcnt(2)
  s_waitcnt lgkmcnt(4)
  v_mfma_f32_32x32x16_bf16 v[16:31], a[120:123], a[100:103], v[16:31]
  v_mfma_f32_32x32x16_bf16 v[32:47], a[100:103], a[124:127], v[32:47]
  s_waitcnt vmcnt(1)
  s_waitcnt lgkmcnt(2)
  v_mfma_f32_32x32x16_bf16 v[16:31], a[128:131], a[104:107], v[16:31]
  v_mfma_f32_32x32x16_bf16 v[32:47], a[104:107], a[132:135], v[32:47]
  s_waitcnt vmcnt(0)
  s_waitcnt lgkmcnt(0)
  v_mfma_f32_32x32x16_bf16 v[16:31], a[136:139], a[108:111], v[16:31]
  v_mfma_f32_32x32x16_bf16 v[32:47], a[108:111], a[140:143], v[32:47]
  ds_write_b32 v7, v12
  ds_write_b32 v7, v15 offset:128
  v_add_u32 v7, s32, v6
  s_waitcnt lgkmcnt(0)
  ds_read_b128 v[144:147], v7 offset:0
  ds_read_b128 v[160:163], v7 offset:128
  ds_read_b128 v[148:151], v7 offset:32
  ds_read_b128 v[164:167], v7 offset:160
  ds_read_b128 v[152:155], v7 offset:64
  ds_read_b128 v[168:171], v7 offset:192
  ds_read_b128 v[156:159], v7 offset:96
  ds_read_b128 v[172:175], v7 offset:224
  v_add_u32 v7, s33, v6
  ds_read_b128 v[88:91], v7 offset:0
  ds_read_b128 v[92:95], v7 offset:32
  ds_read_b128 v[96:99], v7 offset:64
  ds_read_b128 v[100:103], v7 offset:96
  ds_read_b128 v[104:107], v7 offset:128
  ds_read_b128 v[108:111], v7 offset:160
  ds_read_b128 v[112:115], v7 offset:192
  ds_read_b128 v[116:119], v7 offset:224
  v_lshlrev_b32 v13, 2, v2
  v_add_u32 v13, s33, v13
  ds_read_b32 v120, v13 offset:256
  ds_read_b128 a[112:115], v4 offset:0
  ds_read_b128 a[116:119], v4 offset:3072
  ds_read_b128 a[120:123], v4 offset:6144
  ds_read_b128 a[124:127], v4 offset:9216
  ds_read_b128 a[128:131], v4 offset:12288
  ds_read_b128 a[132:135], v4 offset:15360
  ds_read_b128 a[136:139], v4 offset:18432
  ds_read_b128 a[140:143], v4 offset:21504
  s_waitcnt lgkmcnt(7)
  v_mfma_f32_32x32x16_bf16 v[48:63], a[112:115], a[0:3], 0
  ds_read_b128 a[144:147], v4 offset:24576
  s_waitcnt lgkmcnt(7)
  v_mfma_f32_32x32x16_bf16 v[48:63], a[116:119], a[4:7], v[48:63]
  ds_read_b128 a[148:151], v4 offset:27648
  s_waitcnt lgkmcnt(7)
  v_mfma_f32_32x32x16_bf16 v[48:63], a[120:123], a[8:11], v[48:63]
  ds_read_b128 a[112:115], v4 offset:30720
  s_waitcnt lgkmcnt(7)
  v_mfma_f32_32x32x16_bf16 v[48:63], a[124:127], a[12:15], v[48:63]
  ds_read_b128 a[116:119], v4 offset:33792
  s_waitcnt lgkmcnt(7)
  v_mfma_f32_32x32x16_bf16 v[48:63], a[128:131], a[16:19], v[48:63]
  ds_read_b128 a[120:123], v4 offset:36864
  s_waitcnt lgkmcnt(7)
  v_fma_f32 v160, v160, v120, v9
  v_fma_f32 v161, v161, v120, v9
  v_fma_f32 v162, v162, v120, v9
  v_fma_f32 v163, v163, v120, v9
  v_fma_f32 v164, v164, v120, v9
  v_fma_f32 v165, v165, v120, v9
  v_fma_f32 v166, v166, v120, v9
  v_fma_f32 v167, v167, v120, v9
  v_mfma_f32_32x32x16_bf16 v[48:63], a[132:135], a[20:23], v[48:63]
  ds_read_b128 a[124:127], v4 offset:39936
  s_waitcnt lgkmcnt(7)
  v_fma_f32 v168, v168, v120, v9
  v_fma_f32 v169, v169, v120, v9
  v_fma_f32 v170, v170, v120, v9
  v_fma_f32 v171, v171, v120, v9
  v_fma_f32 v172, v172, v120, v9
  v_fma_f32 v173, v173, v120, v9
  v_fma_f32 v174, v174, v120, v9
  v_fma_f32 v175, v175, v120, v9
  v_mfma_f32_32x32x16_bf16 v[48:63], a[136:139], a[24:27], v[48:63]
  ds_read_b128 a[128:131], v4 offset:43008
  s_waitcnt lgkmcnt(7)
  v_pk_fma_f32 v[16:17], v[104:105], v[10:11], v[16:17] op_sel_hi:[1,0,1]
  v_pk_fma_f32 v[18:19], v[106:107], v[10:11], v[18:19] op_sel_hi:[1,0,1]
  v_pk_fma_f32 v[20:21], v[108:109], v[10:11], v[20:21] op_sel_hi:[1,0,1]
  v_pk_fma_f32 v[22:23], v[110:111], v[10:11], v[22:23] op_sel_hi:[1,0,1]
  v_pk_fma_f32 v[24:25], v[112:113], v[10:11], v[24:25] op_sel_hi:[1,0,1]
  v_pk_fma_f32 v[26:27], v[114:115], v[10:11], v[26:27] op_sel_hi:[1,0,1]
  v_pk_fma_f32 v[28:29], v[116:117], v[10:11], v[28:29] op_sel_hi:[1,0,1]
  v_pk_fma_f32 v[30:31], v[118:119], v[10:11], v[30:31] op_sel_hi:[1,0,1]
  v_mfma_f32_32x32x16_bf16 v[48:63], a[140:143], a[28:31], v[48:63]
  ds_read_b128 a[132:135], v4 offset:46080
  s_waitcnt lgkmcnt(7)
  v_pk_mul_f32 v[16:17], v[16:17], v[12:13] op_sel_hi:[1,0]
  v_pk_mul_f32 v[18:19], v[18:19], v[12:13] op_sel_hi:[1,0]
  v_pk_mul_f32 v[20:21], v[20:21], v[12:13] op_sel_hi:[1,0]
  v_pk_mul_f32 v[22:23], v[22:23], v[12:13] op_sel_hi:[1,0]
  v_pk_mul_f32 v[24:25], v[24:25], v[12:13] op_sel_hi:[1,0]
  v_pk_mul_f32 v[26:27], v[26:27], v[12:13] op_sel_hi:[1,0]
  v_pk_mul_f32 v[28:29], v[28:29], v[12:13] op_sel_hi:[1,0]
  v_pk_mul_f32 v[30:31], v[30:31], v[12:13] op_sel_hi:[1,0]
  v_mfma_f32_32x32x16_bf16 v[48:63], a[144:147], a[32:35], v[48:63]
  ds_read_b128 a[136:139], v4 offset:49152
  s_waitcnt lgkmcnt(7)
  v_cvt_pk_bf16_f32 v16, v16, v17
  v_cvt_pk_bf16_f32 v17, v18, v19
  v_cvt_pk_bf16_f32 v18, v20, v21
  v_cvt_pk_bf16_f32 v19, v22, v23
  v_cvt_pk_bf16_f32 v20, v24, v25
  v_cvt_pk_bf16_f32 v21, v26, v27
  v_cvt_pk_bf16_f32 v22, v28, v29
  v_cvt_pk_bf16_f32 v23, v30, v31
  v_mfma_f32_32x32x16_bf16 v[48:63], a[148:151], a[36:39], v[48:63]
  ds_read_b128 a[140:143], v4 offset:52224
  s_waitcnt lgkmcnt(7)
  s_lshl_b32 s31, s27, 6
  s_add_u32 s31, s31, s26
  s_lshl_b32 s31, s31, 12
  s_add_u32 s31, s31, s19
  buffer_store_dwordx4 v[16:19], v4, s[4:7], s31 offen sc1
  buffer_store_dwordx4 v[20:23], v4, s[4:7], s31 offen offset:1024 sc1
  v_fma_f32 v32, v32, v144, v160
  v_fma_f32 v33, v33, v145, v161
  v_mfma_f32_32x32x16_bf16 v[48:63], a[112:115], a[40:43], v[48:63]
  ds_read_b128 a[144:147], v4 offset:55296
  s_waitcnt lgkmcnt(7)
  v_fma_f32 v34, v34, v146, v162
  v_fma_f32 v35, v35, v147, v163
  v_fma_f32 v36, v36, v148, v164
  v_fma_f32 v37, v37, v149, v165
  v_fma_f32 v38, v38, v150, v166
  v_fma_f32 v39, v39, v151, v167
  v_fma_f32 v40, v40, v152, v168
  v_fma_f32 v41, v41, v153, v169
  v_mfma_f32_32x32x16_bf16 v[48:63], a[116:119], a[44:47], v[48:63]
  ds_read_b128 a[148:151], v4 offset:58368
  s_waitcnt lgkmcnt(7)
  v_fma_f32 v42, v42, v154, v170
  v_fma_f32 v43, v43, v155, v171
  v_fma_f32 v44, v44, v156, v172
  v_fma_f32 v45, v45, v157, v173
  v_fma_f32 v46, v46, v158, v174
  v_fma_f32 v47, v47, v159, v175
  v_cvt_pk_bf16_f32 v32, v32, v33
  v_cvt_pk_bf16_f32 v33, v34, v35
  v_mfma_f32_32x32x16_bf16 v[48:63], a[120:123], a[48:51], v[48:63]
  ds_read_b128 a[112:115], v4 offset:61440
  s_waitcnt lgkmcnt(7)
  v_cvt_pk_bf16_f32 v34, v36, v37
  v_cvt_pk_bf16_f32 v35, v38, v39
  v_cvt_pk_bf16_f32 v36, v40, v41
  v_cvt_pk_bf16_f32 v37, v42, v43
  v_cvt_pk_bf16_f32 v38, v44, v45
  v_cvt_pk_bf16_f32 v39, v46, v47
  buffer_store_dwordx4 v[32:35], v4, s[4:7], s31 offen offset:2048 sc1
  buffer_store_dwordx4 v[36:39], v4, s[4:7], s31 offen offset:3072 sc1
  v_mfma_f32_32x32x16_bf16 v[48:63], a[124:127], a[52:55], v[48:63]
  ds_read_b128 a[116:119], v4 offset:64512
  s_waitcnt lgkmcnt(7)
  v_mfma_f32_32x32x16_bf16 v[48:63], a[128:131], a[56:59], v[48:63]
  ds_read_b128 a[120:123], v8 offset:2048
  s_waitcnt lgkmcnt(7)
  v_mfma_f32_32x32x16_bf16 v[48:63], a[132:135], a[60:63], v[48:63]
  ds_read_b128 a[124:127], v8 offset:5120
  s_waitcnt lgkmcnt(7)
  v_mfma_f32_32x32x16_bf16 v[48:63], a[136:139], a[64:67], v[48:63]
  ds_read_b128 a[128:131], v8 offset:8192
  s_waitcnt lgkmcnt(7)
  v_mfma_f32_32x32x16_bf16 v[48:63], a[140:143], a[68:71], v[48:63]
  ds_read_b128 a[132:135], v8 offset:11264
  s_waitcnt lgkmcnt(7)
  v_mfma_f32_32x32x16_bf16 v[48:63], a[144:147], a[72:75], v[48:63]
  ds_read_b128 a[136:139], v8 offset:14336
  s_waitcnt lgkmcnt(7)
  v_mfma_f32_32x32x16_bf16 v[48:63], a[148:151], a[76:79], v[48:63]
  ds_read_b128 a[140:143], v8 offset:17408
  s_waitcnt lgkmcnt(7)
  v_mfma_f32_32x32x16_bf16 v[48:63], a[112:115], a[80:83], v[48:63]
  s_waitcnt lgkmcnt(6)
  v_mfma_f32_32x32x16_bf16 v[48:63], a[116:119], a[84:87], v[48:63]
  s_waitcnt lgkmcnt(5)
  v_mfma_f32_32x32x16_bf16 v[48:63], a[120:123], a[88:91], v[48:63]
  s_waitcnt lgkmcnt(4)
  v_mfma_f32_32x32x16_bf16 v[48:63], a[124:127], a[92:95], v[48:63]
  s_waitcnt lgkmcnt(3)
  v_mfma_f32_32x32x16_bf16 v[48:63], a[128:131], a[96:99], v[48:63]
  s_waitcnt lgkmcnt(2)
  v_mfma_f32_32x32x16_bf16 v[48:63], a[132:135], a[100:103], v[48:63]
  s_waitcnt lgkmcnt(1)
  v_mfma_f32_32x32x16_bf16 v[48:63], a[136:139], a[104:107], v[48:63]
  s_waitcnt lgkmcnt(0)
  v_mfma_f32_32x32x16_bf16 v[48:63], a[140:143], a[108:111], v[48:63]
  s_waitcnt vmcnt(0)
  s_barrier
  s_lshl_b32 s30, s14, 4
  s_add_u32 s30, s30, s27
  s_lshl_b32 s30, s30, 7
  s_add_u32 s30, s30, 0x4e2000
  s_cmp_lg_u32 s3, 0
  s_cbranch_scc1 kv_noarr
  s_add_u32 s69, s67, 9
  s_add_u32 s69, s69, s14
  s_lshr_b32 s31, s26, 2
  s_lshl_b32 s31, s31, 2
  s_add_u32 s31, s31, s30
  v_mov_b32 v6, s69
  v_mov_b32 v7, 0
  s_mov_b64 exec, 1
  buffer_store_dword v6, v7, s[4:7], s31 offen sc0 sc1
  s_mov_b64 exec, -1
kv_noarr:
  s_nop 5
  v_pk_fma_f32 v[48:49], v[88:89], v[10:11], v[48:49] op_sel_hi:[1,0,1]
  v_pk_fma_f32 v[50:51], v[90:91], v[10:11], v[50:51] op_sel_hi:[1,0,1]
  v_pk_fma_f32 v[52:53], v[92:93], v[10:11], v[52:53] op_sel_hi:[1,0,1]
  v_pk_fma_f32 v[54:55], v[94:95], v[10:11], v[54:55] op_sel_hi:[1,0,1]
  v_pk_fma_f32 v[56:57], v[96:97], v[10:11], v[56:57] op_sel_hi:[1,0,1]
  v_pk_fma_f32 v[58:59], v[98:99], v[10:11], v[58:59] op_sel_hi:[1,0,1]
  v_pk_fma_f32 v[60:61], v[100:101], v[10:11], v[60:61] op_sel_hi:[1,0,1]
  v_pk_fma_f32 v[62:63], v[102:103], v[10:11], v[62:63] op_sel_hi:[1,0,1]
  v_pk_mul_f32 v[48:49], v[48:49], v[14:15] op_sel_hi:[1,0]
  v_pk_mul_f32 v[50:51], v[50:51], v[14:15] op_sel_hi:[1,0]
  v_pk_mul_f32 v[52:53], v[52:53], v[14:15] op_sel_hi:[1,0]
  v_pk_mul_f32 v[54:55], v[54:55], v[14:15] op_sel_hi:[1,0]
  v_pk_mul_f32 v[56:57], v[56:57], v[14:15] op_sel_hi:[1,0]
  v_pk_mul_f32 v[58:59], v[58:59], v[14:15] op_sel_hi:[1,0]
  v_pk_mul_f32 v[60:61], v[60:61], v[14:15] op_sel_hi:[1,0]
  v_pk_mul_f32 v[62:63], v[62:63], v[14:15] op_sel_hi:[1,0]
  v_cvt_pk_bf16_f32 v136, v48, v49
  v_cvt_pk_bf16_f32 v137, v50, v51
  v_cvt_pk_bf16_f32 v138, v52, v53
  v_cvt_pk_bf16_f32 v139, v54, v55
  v_cvt_pk_bf16_f32 v140, v56, v57
  v_cvt_pk_bf16_f32 v141, v58, v59
  v_cvt_pk_bf16_f32 v142, v60, v61
  v_cvt_pk_bf16_f32 v143, v62, v63
  s_cmp_lg_u32 s14, 0
  s_cbranch_scc1 pd_skip
  s_cmp_ge_u32 s13, 28
  s_cbranch_scc1 pd_skip
  s_cmp_lg_u32 s3, 0
  s_cbranch_scc1 pd_bar
  s_lshl_b32 s31, s29, 2
  s_add_u32 s31, s31, 160
  v_add_u32 v8, s31, v0
  s_lshl_b32 s31, s29, 3
  s_add_u32 s31, s31, 100
  v_add_u32 v9, s31, v0
  v_cmp_le_u32 vcc, 4, v0
  s_nop 1
  v_cndmask_b32 v8, v8, v9, vcc
  s_lshl_b32 s31, s27, 2
  s_add_u32 s31, s31, 36
  v_add_u32 v9, s31, v0
  v_cmp_le_u32 vcc, 12, v0
  s_nop 1
  v_cndmask_b32 v8, v8, v9, vcc
  s_lshl_b32 s31, s28, 1
  s_add_u32 s31, s31, 172
  v_add_u32 v9, s31, v0
  v_cmp_le_u32 vcc, 16, v0
  s_nop 1
  v_cndmask_b32 v8, v8, v9, vcc
  v_lshlrev_b32 v8, 6, v8
  v_add_u32 v8, 0x4e4000, v8
  s_mov_b64 exec, 0x3ffff
  s_mov_b32 s42, 0
dp_3:
  s_add_u32 s42, s42, 1
  s_cmp_gt_u32 s42, 0x40000
  s_cbranch_scc1 dpd_4
  buffer_load_dword v9, v8, s[4:7], 0 offen sc0 sc1
  s_waitcnt vmcnt(0)
  v_cmp_ne_u32 vcc, s68, v9
  s_cbranch_vccnz dp_3
dpd_4:
  s_mov_b64 exec, -1
pd_bar:
  s_barrier
pd_skip:
  s_mul_i32 s44, s29, 65536
  s_lshl_b32 s45, s3, 13
  s_add_u32 s44, s44, s45
  s_add_u32 s44, s44, 0x150000
  s_add_u32 s45, s44, 32768
  s_mul_i32 s46, s29, 229376
  s_mul_i32 s47, s3, 28672
  s_add_u32 s46, s46, s47
  s_add_u32 s46, s46, 0x348000
  s_add_u32 s47, s46, 114688
  buffer_load_dwordx4 v[192:195], v4, s[4:7], s44 offen offset:0
  buffer_load_dwordx4 v[196:199], v4, s[4:7], s45 offen offset:0
  buffer_load_dwordx4 v[200:203], v4, s[4:7], s44 offen offset:1024
  buffer_load_dwordx4 v[204:207], v4, s[4:7], s45 offen offset:1024
  buffer_load_dwordx4 v[208:211], v4, s[4:7], s44 offen offset:2048
  buffer_load_dwordx4 v[212:215], v4, s[4:7], s45 offen offset:2048
  buffer_load_dwordx4 v[216:219], v4, s[4:7], s44 offen offset:3072
  buffer_load_dwordx4 v[220:223], v4, s[4:7], s45 offen offset:3072
  s_add_u32 s44, s44, 4096
  s_add_u32 s45, s45, 4096
  buffer_load_dwordx4 v[224:227], v4, s[4:7], s44 offen offset:0
  buffer_load_dwordx4 v[228:231], v4, s[4:7], s45 offen offset:0
  buffer_load_dwordx4 v[232:235], v4, s[4:7], s44 offen offset:1024
  buffer_load_dwordx4 v[236:239], v4, s[4:7], s45 offen offset:1024
  buffer_load_dwordx4 v[240:243], v4, s[4:7], s44 offen offset:2048
  buffer_load_dwordx4 v[244:247], v4, s[4:7], s45 offen offset:2048
  buffer_load_dwordx4 v[248:251], v4, s[4:7], s44 offen offset:3072
  buffer_load_dwordx4 v[252:255], v4, s[4:7], s45 offen offset:3072
  s_cmp_lg_u32 s3, 0
  s_cbranch_scc1 kv_wait_end
  v_lshlrev_b32 v8, 2, v0
  v_add_u32 v8, s30, v8
  s_mov_b64 exec, 0xffff
  s_mov_b32 s42, 0
dp_5:
  s_add_u32 s42, s42, 1
  s_cmp_gt_u32 s42, 0x40000
  s_cbranch_scc1 dpd_6
  buffer_load_dword v9, v8, s[4:7], 0 offen sc0 sc1
  s_waitcnt vmcnt(0)
  v_cmp_ne_u32 vcc, s69, v9
  s_cbranch_vccnz dp_5
dpd_6:
  s_mov_b64 exec, -1
kv_wait_end:
  s_barrier
  s_lshl_b32 s55, s27, 6
  s_add_u32 s55, s55, s3
  s_lshl_b32 s55, s55, 12
  s_add_u32 s55, s55, s19
  s_mov_b32 s56, 0
  s_lshl_b32 s31, s3, 12
  s_lshl_b32 s33, s56, 14
  s_add_u32 s33, s33, s55
  s_add_u32 s56, s56, 1
  s_and_b32 s56, s56, 15
  s_add_u32 m0, s31, 0
  s_nop 0
  buffer_load_dwordx4 v4, s[4:7], s33 offen offset:0 lds
  buffer_load_dwordx4 v4, s[4:7], s33 offen offset:1024 lds
  buffer_load_dwordx4 v4, s[4:7], s33 offen offset:2048 lds
  buffer_load_dwordx4 v4, s[4:7], s33 offen offset:3072 lds
  s_lshl_b32 s34, s56, 14
  s_add_u32 s34, s34, s55
  s_add_u32 s56, s56, 1
  s_and_b32 s56, s56, 15
  s_add_u32 m0, s31, 16384
  s_nop 0
  buffer_load_dwordx4 v4, s[4:7], s34 offen offset:0 lds
  buffer_load_dwordx4 v4, s[4:7], s34 offen offset:1024 lds
  buffer_load_dwordx4 v4, s[4:7], s34 offen offset:2048 lds
  buffer_load_dwordx4 v4, s[4:7], s34 offen offset:3072 lds
  s_lshl_b32 s33, s56, 14
  s_add_u32 s33, s33, s55
  s_add_u32 s56, s56, 1
  s_and_b32 s56, s56, 15
  s_add_u32 m0, s31, 32768
  s_nop 0
  buffer_load_dwordx4 v4, s[4:7], s33 offen offset:0 lds
  buffer_load_dwordx4 v4, s[4:7], s33 offen offset:1024 lds
  buffer_load_dwordx4 v4, s[4:7], s33 offen offset:2048 lds
  buffer_load_dwordx4 v4, s[4:7], s33 offen offset:3072 lds
  v_mov_b32 v104, 0
  v_mov_b32 v105, 0
  v_mov_b32 v106, 0
  v_mov_b32 v107, 0
  v_mov_b32 v108, 0
  v_mov_b32 v109, 0
  v_mov_b32 v110, 0
  v_mov_b32 v111, 0
  v_mov_b32 v112, 0
  v_mov_b32 v113, 0
  v_mov_b32 v114, 0
  v_mov_b32 v115, 0
  v_mov_b32 v116, 0
  v_mov_b32 v117, 0
  v_mov_b32 v118, 0
  v_mov_b32 v119, 0
  v_mov_b32 v5, v4
  v_add_u32 v6, 0x10000, v4
  v_lshlrev_b32 v13, 7, v0
  v_mov_b32 v10, 0x7f000000
  v_cmp_gt_u32 vcc, 16, v0
  s_nop 1
  v_cndmask_b32 v13, v10, v13, vcc
  s_waitcnt vmcnt(8)
  s_barrier
  ds_read_b128 v[16:19], v5 offset:0
  ds_read_b128 v[20:23], v5 offset:1024
  ds_read_b128 v[24:27], v5 offset:4096
  ds_read_b128 v[28:31], v5 offset:5120
  ds_read_b128 v[40:43], v5 offset:2048
  ds_read_b128 v[44:47], v5 offset:3072
  s_waitcnt lgkmcnt(4)
  v_mfma_f32_32x32x16_bf16 v[64:79], v[16:19], v[136:139], 0
  v_mfma_f32_32x32x16_bf16 v[64:79], v[20:23], v[140:143], v[64:79]
  ds_read_b128 v[32:35], v5 offset:8192
  ds_read_b128 v[36:39], v5 offset:9216
  ds_read_b128 v[48:51], v5 offset:6144
  ds_read_b128 v[52:55], v5 offset:7168
  s_nop 7
  s_nop 3
  v_max3_f32 v120, v64, v65, v66
  v_max3_f32 v120, v120, v67, v68
  v_max3_f32 v120, v120, v69, v70
  v_max3_f32 v120, v120, v71, v72
  v_max3_f32 v120, v120, v73, v74
  v_max3_f32 v120, v120, v75, v76
  v_max3_f32 v120, v120, v77, v78
  v_max_f32 v120, v120, v79
  v_mov_b32 v121, v120
  s_nop 1
  v_permlane32_swap_b32 v120, v121
  s_nop 1
  v_max_f32 v7, v120, v121
  v_sub_f32 v120, 0, v7
  v_sub_f32 v121, 0, v7
  v_sub_f32 v122, 0, v7
  v_sub_f32 v123, 0, v7
  v_sub_f32 v124, 0, v7
  v_sub_f32 v125, 0, v7
  v_sub_f32 v126, 0, v7
  v_sub_f32 v127, 0, v7
  v_sub_f32 v128, 0, v7
  v_sub_f32 v129, 0, v7
  v_sub_f32 v130, 0, v7
  v_sub_f32 v131, 0, v7
  v_sub_f32 v132, 0, v7
  v_sub_f32 v133, 0, v7
  v_sub_f32 v134, 0, v7
  v_sub_f32 v135, 0, v7
  v_sub_f32 v64, v64, v7
  v_sub_f32 v65, v65, v7
  v_sub_f32 v66, v66, v7
  v_sub_f32 v67, v67, v7
  v_sub_f32 v68, v68, v7
  v_sub_f32 v69, v69, v7
  v_sub_f32 v70, v70, v7
  v_sub_f32 v71, v71, v7
  v_sub_f32 v72, v72, v7
  v_sub_f32 v73, v73, v7
  v_sub_f32 v74, v74, v7
  v_sub_f32 v75, v75, v7
  v_sub_f32 v76, v76, v7
  v_sub_f32 v77, v77, v7
  v_sub_f32 v78, v78, v7
  v_sub_f32 v79, v79, v7
  s_waitcnt lgkmcnt(0)
  v_mfma_f32_32x32x16_bf16 v[80:95], v[24:27], v[136:139], v[120:135]
  ds_read_b128 v[16:19], v5 offset:12288
  v_exp_f32 v64, v64
  v_exp_f32 v65, v65
  v_exp_f32 v66, v66
  v_exp_f32 v67, v67
  ds_read_b128 v[20:23], v5 offset:13312
  v_exp_f32 v68, v68
  v_exp_f32 v69, v69
  v_exp_f32 v70, v70
  v_exp_f32 v71, v71
  v_mfma_f32_32x32x16_bf16 v[80:95], v[28:31], v[140:143], v[80:95]
  ds_read_b128 v[56:59], v5 offset:10240
  v_cvt_pk_bf16_f32 v96, v64, v65
  v_cvt_pk_bf16_f32 v97, v66, v67
  v_cvt_pk_bf16_f32 v98, v68, v69
  v_cvt_pk_bf16_f32 v99, v70, v71
  v_exp_f32 v72, v72
  v_exp_f32 v73, v73
  v_exp_f32 v74, v74
  v_exp_f32 v75, v75
  v_mfma_f32_32x32x16_bf16 v[104:119], v[40:43], v[96:99], v[104:119]
  ds_read_b128 v[60:63], v5 offset:11264
  v_exp_f32 v76, v76
  v_exp_f32 v77, v77
  v_exp_f32 v78, v78
  v_exp_f32 v79, v79
  s_waitcnt lgkmcnt(4)
  v_cvt_pk_bf16_f32 v100, v72, v73
  v_cvt_pk_bf16_f32 v101, v74, v75
  v_cvt_pk_bf16_f32 v102, v76, v77
  v_cvt_pk_bf16_f32 v103, v78, v79
  v_mfma_f32_32x32x16_bf16 v[64:79], v[32:35], v[136:139], v[120:135]
  s_waitcnt vmcnt(4)
  s_barrier
  ds_read_b128 v[24:27], v5 offset:16384
  v_exp_f32 v80, v80
  v_exp_f32 v81, v81
  v_exp_f32 v82, v82
  v_exp_f32 v83, v83
  v_mfma_f32_32x32x16_bf16 v[104:119], v[44:47], v[100:103], v[104:119]
  s_lshl_b32 s34, s56, 14
  s_add_u32 s34, s34, s55
  s_add_u32 s56, s56, 1
  s_and_b32 s56, s56, 15
  s_add_u32 m0, s31, 49152
  s_nop 0
  buffer_load_dwordx4 v4, s[4:7], s34 offen offset:0 lds
  ds_read_b128 v[28:31], v5 offset:17408
  v_exp_f32 v84, v84
  v_exp_f32 v85, v85
  v_exp_f32 v86, v86
  v_exp_f32 v87, v87
  v_mfma_f32_32x32x16_bf16 v[64:79], v[36:39], v[140:143], v[64:79]
  buffer_load_dwordx4 v4, s[4:7], s34 offen offset:1024 lds
  ds_read_b128 v[40:43], v5 offset:14336
  v_cvt_pk_bf16_f32 v96, v80, v81
  v_cvt_pk_bf16_f32 v97, v82, v83
  v_cvt_pk_bf16_f32 v98, v84, v85
  v_cvt_pk_bf16_f32 v99, v86, v87
  v_exp_f32 v88, v88
  v_exp_f32 v89, v89
  v_exp_f32 v90, v90
  v_exp_f32 v91, v91
  v_mfma_f32_32x32x16_bf16 v[104:119], v[48:51], v[96:99], v[104:119]
  ds_read_b128 v[44:47], v5 offset:15360
  v_exp_f32 v92, v92
  v_exp_f32 v93, v93
  v_exp_f32 v94, v94
  v_exp_f32 v95, v95
  s_waitcnt lgkmcnt(4)
  v_cvt_pk_bf16_f32 v100, v88, v89
  v_cvt_pk_bf16_f32 v101, v90, v91
  v_cvt_pk_bf16_f32 v102, v92, v93
  v_cvt_pk_bf16_f32 v103, v94, v95
  v_mfma_f32_32x32x16_bf16 v[80:95], v[16:19], v[136:139], v[120:135]
  ds_read_b128 v[32:35], v5 offset:20480
  v_exp_f32 v64, v64
  v_exp_f32 v65, v65
  v_exp_f32 v66, v66
  v_exp_f32 v67, v67
  v_mfma_f32_32x32x16_bf16 v[104:119], v[52:55], v[100:103], v[104:119]
  buffer_load_dwordx4 v4, s[4:7], s34 offen offset:2048 lds
  ds_read_b128 v[36:39], v5 offset:21504
  v_exp_f32 v68, v68
  v_exp_f32 v69, v69
  v_exp_f32 v70, v70
  v_exp_f32 v71, v71
  v_mfma_f32_32x32x16_bf16 v[80:95], v[20:23], v[140:143], v[80:95]
  buffer_load_dwordx4 v4, s[4:7], s34 offen offset:3072 lds
  ds_read_b128 v[48:51], v5 offset:18432
  v_cvt_pk_bf16_f32 v96, v64, v65
  v_cvt_pk_bf16_f32 v97, v66, v67
  v_cvt_pk_bf16_f32 v98, v68, v69
  v_cvt_pk_bf16_f32 v99, v70, v71
  v_exp_f32 v72, v72
  v_exp_f32 v73, v73
  v_exp_f32 v74, v74
  v_exp_f32 v75, v75
  v_mfma_f32_32x32x16_bf16 v[104:119], v[56:59], v[96:99], v[104:119]
  ds_read_b128 v[52:55], v5 offset:19456
  v_exp_f32 v76, v76
  v_exp_f32 v77, v77
  v_exp_f32 v78, v78
  v_exp_f32 v79, v79
  s_waitcnt lgkmcnt(4)
  v_cvt_pk_bf16_f32 v100, v72, v73
  v_cvt_pk_bf16_f32 v101, v74, v75
  v_cvt_pk_bf16_f32 v102, v76, v77
  v_cvt_pk_bf16_f32 v103, v78, v79
  v_mfma_f32_32x32x16_bf16 v[64:79], v[24:27], v[136:139], v[120:135]
  ds_read_b128 v[16:19], v5 offset:24576
  v_exp_f32 v80, v80
  v_exp_f32 v81, v81
  v_exp_f32 v82, v82
  v_exp_f32 v83, v83
  v_mfma_f32_32x32x16_bf16 v[104:119], v[60:63], v[100:103], v[104:119]
  ds_read_b128 v[20:23], v5 offset:25600
  v_exp_f32 v84, v84
  v_exp_f32 v85, v85
  v_exp_f32 v86, v86
  v_exp_f32 v87, v87
  v_mfma_f32_32x32x16_bf16 v[64:79], v[28:31], v[140:143], v[64:79]
  s_lshl_b32 s33, s56, 14
  s_add_u32 s33, s33, s55
  s_add_u32 s56, s56, 1
  s_and_b32 s56, s56, 15
  s_add_u32 m0, s31, 65536
  s_nop 0
  buffer_load_dwordx4 v4, s[4:7], s33 offen offset:0 lds
  ds_read_b128 v[56:59], v5 offset:22528
  v_cvt_pk_bf16_f32 v96, v80, v81
  v_cvt_pk_bf16_f32 v97, v82, v83
  v_cvt_pk_bf16_f32 v98, v84, v85
  v_cvt_pk_bf16_f32 v99, v86, v87
  v_exp_f32 v88, v88
  v_exp_f32 v89, v89
  v_exp_f32 v90, v90
  v_exp_f32 v91, v91
  v_mfma_f32_32x32x16_bf16 v[104:119], v[40:43], v[96:99], v[104:119]
  ds_read_b128 v[60:63], v5 offset:23552
  v_exp_f32 v92, v92
  v_exp_f32 v93, v93
  v_exp_f32 v94, v94
  v_exp_f32 v95, v95
  s_waitcnt lgkmcnt(4)
  v_cvt_pk_bf16_f32 v100, v88, v89
  v_cvt_pk_bf16_f32 v101, v90, v91
  v_cvt_pk_bf16_f32 v102, v92, v93
  v_cvt_pk_bf16_f32 v103, v94, v95
  v_mfma_f32_32x32x16_bf16 v[80:95], v[32:35], v[136:139], v[120:135]
  ds_read_b128 v[24:27], v5 offset:28672
  v_exp_f32 v64, v64
  v_exp_f32 v65, v65
  v_exp_f32 v66, v66
  v_exp_f32 v67, v67
  v_mfma_f32_32x32x16_bf16 v[104:119], v[44:47], v[100:103], v[104:119]
  ds_read_b128 v[28:31], v5 offset:29696
  v_exp_f32 v68, v68
  v_exp_f32 v69, v69
  v_exp_f32 v70, v70
  v_exp_f32 v71, v71
  v_mfma_f32_32x32x16_bf16 v[80:95], v[36:39], v[140:143], v[80:95]
  buffer_load_dwordx4 v4, s[4:7], s33 offen offset:1024 lds
  ds_read_b128 v[40:43], v5 offset:26624
  v_cvt_pk_bf16_f32 v96, v64, v65
  v_cvt_pk_bf16_f32 v97, v66, v67
  v_cvt_pk_bf16_f32 v98, v68, v69
  v_cvt_pk_bf16_f32 v99, v70, v71
  v_exp_f32 v72, v72
  v_exp_f32 v73, v73
  v_exp_f32 v74, v74
  v_exp_f32 v75, v75
  v_mfma_f32_32x32x16_bf16 v[104:119], v[48:51], v[96:99], v[104:119]
  ds_read_b128 v[44:47], v5 offset:27648
  v_exp_f32 v76, v76
  v_exp_f32 v77, v77
  v_exp_f32 v78, v78
  v_exp_f32 v79, v79
  s_waitcnt lgkmcnt(4)
  v_cvt_pk_bf16_f32 v100, v72, v73
  v_cvt_pk_bf16_f32 v101, v74, v75
  v_cvt_pk_bf16_f32 v102, v76, v77
  v_cvt_pk_bf16_f32 v103, v78, v79
  v_mfma_f32_32x32x16_bf16 v[64:79], v[16:19], v[136:139], v[120:135]
  s_waitcnt vmcnt(6)
  s_barrier
  ds_read_b128 v[32:35], v5 offset:32768
  v_exp_f32 v80, v80
  v_exp_f32 v81, v81
  v_exp_f32 v82, v82
  v_exp_f32 v83, v83
  v_mfma_f32_32x32x16_bf16 v[104:119], v[52:55], v[100:103], v[104:119]
  buffer_load_dwordx4 v4, s[4:7], s33 offen offset:2048 lds
  ds_read_b128 v[36:39], v5 offset:33792
  v_exp_f32 v84, v84
  v_exp_f32 v85, v85
  v_exp_f32 v86, v86
  v_exp_f32 v87, v87
  v_mfma_f32_32x32x16_bf16 v[64:79], v[20:23], v[140:143], v[64:79]
  buffer_load_dwordx4 v4, s[4:7], s33 offen offset:3072 lds
  ds_read_b128 v[48:51], v5 offset:30720
  v_cvt_pk_bf16_f32 v96, v80, v81
  v_cvt_pk_bf16_f32 v97, v82, v83
  v_cvt_pk_bf16_f32 v98, v84, v85
  v_cvt_pk_bf16_f32 v99, v86, v87
  v_exp_f32 v88, v88
  v_exp_f32 v89, v89
  v_exp_f32 v90, v90
  v_exp_f32 v91, v91
  v_mfma_f32_32x32x16_bf16 v[104:119], v[56:59], v[96:99], v[104:119]
  ds_read_b128 v[52:55], v5 offset:31744
  v_exp_f32 v92, v92
  v_exp_f32 v93, v93
  v_exp_f32 v94, v94
  v_exp_f32 v95, v95
  s_waitcnt lgkmcnt(4)
  v_cvt_pk_bf16_f32 v100, v88, v89
  v_cvt_pk_bf16_f32 v101, v90, v91
  v_cvt_pk_bf16_f32 v102, v92, v93
  v_cvt_pk_bf16_f32 v103, v94, v95
  v_mfma_f32_32x32x16_bf16 v[80:95], v[24:27], v[136:139], v[120:135]
  buffer_load_dwordx4 a[0:3], v4, s[4:7], s46 offen offset:0
  ds_read_b128 v[16:19], v5 offset:36864
  v_exp_f32 v64, v64
  v_exp_f32 v65, v65
  v_exp_f32 v66, v66
  v_exp_f32 v67, v67
  v_mfma_f32_32x32x16_bf16 v[104:119], v[60:63], v[100:103], v[104:119]
  s_lshl_b32 s34, s56, 14
  s_add_u32 s34, s34, s55
  s_add_u32 s56, s56, 1
  s_and_b32 s56, s56, 15
  s_add_u32 m0, s31, 81920
  s_nop 0
  buffer_load_dwordx4 v4, s[4:7], s34 offen offset:0 lds
  ds_read_b128 v[20:23], v5 offset:37888
  v_exp_f32 v68, v68
  v_exp_f32 v69, v69
  v_exp_f32 v70, v70
  v_exp_f32 v71, v71
  v_mfma_f32_32x32x16_bf16 v[80:95], v[28:31], v[140:143], v[80:95]
  buffer_load_dwordx4 v4, s[4:7], s34 offen offset:1024 lds
  ds_read_b128 v[56:59], v5 offset:34816
  v_cvt_pk_bf16_f32 v96, v64, v65
  v_cvt_pk_bf16_f32 v97, v66, v67
  v_cvt_pk_bf16_f32 v98, v68, v69
  v_cvt_pk_bf16_f32 v99, v70, v71
  v_exp_f32 v72, v72
  v_exp_f32 v73, v73
  v_exp_f32 v74, v74
  v_exp_f32 v75, v75
  v_mfma_f32_32x32x16_bf16 v[104:119], v[40:43], v[96:99], v[104:119]
  ds_read_b128 v[60:63], v5 offset:35840
  v_exp_f32 v76, v76
  v_exp_f32 v77, v77
  v_exp_f32 v78, v78
  v_exp_f32 v79, v79
  s_waitcnt lgkmcnt(4)
  v_cvt_pk_bf16_f32 v100, v72, v73
  v_cvt_pk_bf16_f32 v101, v74, v75
  v_cvt_pk_bf16_f32 v102, v76, v77
  v_cvt_pk_bf16_f32 v103, v78, v79
  v_mfma_f32_32x32x16_bf16 v[64:79], v[32:35], v[136:139], v[120:135]
  buffer_load_dwordx4 a[4:7], v4, s[4:7], s47 offen offset:0
  ds_read_b128 v[24:27], v5 offset:40960
  v_exp_f32 v80, v80
  v_exp_f32 v81, v81
  v_exp_f32 v82, v82
  v_exp_f32 v83, v83
  v_mfma_f32_32x32x16_bf16 v[104:119], v[44:47], v[100:103], v[104:119]
  buffer_load_dwordx4 v4, s[4:7], s34 offen offset:2048 lds
  ds_read_b128 v[28:31], v5 offset:41984
  v_exp_f32 v84, v84
  v_exp_f32 v85, v85
  v_exp_f32 v86, v86
  v_exp_f32 v87, v87
  v_mfma_f32_32x32x16_bf16 v[64:79], v[36:39], v[140:143], v[64:79]
  buffer_load_dwordx4 v4, s[4:7], s34 offen offset:3072 lds
  ds_read_b128 v[40:43], v5 offset:38912
  v_cvt_pk_bf16_f32 v96, v80, v81
  v_cvt_pk_bf16_f32 v97, v82, v83
  v_cvt_pk_bf16_f32 v98, v84, v85
  v_cvt_pk_bf16_f32 v99, v86, v87
  v_exp_f32 v88, v88
  v_exp_f32 v89, v89
  v_exp_f32 v90, v90
  v_exp_f32 v91, v91
  v_mfma_f32_32x32x16_bf16 v[104:119], v[48:51], v[96:99], v[104:119]
  ds_read_b128 v[44:47], v5 offset:39936
  v_exp_f32 v92, v92
  v_exp_f32 v93, v93
  v_exp_f32 v94, v94
  v_exp_f32 v95, v95
  s_waitcnt lgkmcnt(4)
  v_cvt_pk_bf16_f32 v100, v88, v89
  v_cvt_pk_bf16_f32 v101, v90, v91
  v_cvt_pk_bf16_f32 v102, v92, v93
  v_cvt_pk_bf16_f32 v103, v94, v95
  v_mfma_f32_32x32x16_bf16 v[80:95], v[16:19], v[136:139], v[120:135]
  buffer_load_dwordx4 a[8:11], v4, s[4:7], s46 offen offset:1024
  ds_read_b128 v[32:35], v5 offset:45056
  v_exp_f32 v64, v64
  v_exp_f32 v65, v65
  v_exp_f32 v66, v66
  v_exp_f32 v67, v67
  v_mfma_f32_32x32x16_bf16 v[104:119], v[52:55], v[100:103], v[104:119]
  ds_read_b128 v[36:39], v5 offset:46080
  v_exp_f32 v68, v68
  v_exp_f32 v69, v69
  v_exp_f32 v70, v70
  v_exp_f32 v71, v71
  v_mfma_f32_32x32x16_bf16 v[80:95], v[20:23], v[140:143], v[80:95]
  s_lshl_b32 s33, s56, 14
  s_add_u32 s33, s33, s55
  s_add_u32 s56, s56, 1
  s_and_b32 s56, s56, 15
  s_add_u32 m0, s31, 98304
  s_nop 0
  buffer_load_dwordx4 v4, s[4:7], s33 offen offset:0 lds
  ds_read_b128 v[48:51], v5 offset:43008
  v_cvt_pk_bf16_f32 v96, v64, v65
  v_cvt_pk_bf16_f32 v97, v66, v67
  v_cvt_pk_bf16_f32 v98, v68, v69
  v_cvt_pk_bf16_f32 v99, v70, v71
  v_exp_f32 v72, v72
  v_exp_f32 v73, v73
  v_exp_f32 v74, v74
  v_exp_f32 v75, v75
  v_mfma_f32_32x32x16_bf16 v[104:119], v[56:59], v[96:99], v[104:119]
  ds_read_b128 v[52:55], v5 offset:44032
  v_exp_f32 v76, v76
  v_exp_f32 v77, v77
  v_exp_f32 v78, v78
  v_exp_f32 v79, v79
  s_waitcnt lgkmcnt(4)
  v_cvt_pk_bf16_f32 v100, v72, v73
  v_cvt_pk_bf16_f32 v101, v74, v75
  v_cvt_pk_bf16_f32 v102, v76, v77
  v_cvt_pk_bf16_f32 v103, v78, v79
  v_mfma_f32_32x32x16_bf16 v[64:79], v[24:27], v[136:139], v[120:135]
  s_waitcnt vmcnt(12)
  s_barrier
  buffer_load_dwordx4 a[12:15], v4, s[4:7], s47 offen offset:1024
  ds_read_b128 v[16:19], v5 offset:49152
  v_exp_f32 v80, v80
  v_exp_f32 v81, v81
  v_exp_f32 v82, v82
  v_exp_f32 v83, v83
  v_mfma_f32_32x32x16_bf16 v[104:119], v[60:63], v[100:103], v[104:119]
  buffer_load_dwordx4 v4, s[4:7], s33 offen offset:1024 lds
  ds_read_b128 v[20:23], v5 offset:50176
  v_exp_f32 v84, v84
  v_exp_f32 v85, v85
  v_exp_f32 v86, v86
  v_exp_f32 v87, v87
  v_mfma_f32_32x32x16_bf16 v[64:79], v[28:31], v[140:143], v[64:79]
  buffer_load_dwordx4 v4, s[4:7], s33 offen offset:2048 lds
  ds_read_b128 v[56:59], v5 offset:47104
  v_cvt_pk_bf16_f32 v96, v80, v81
  v_cvt_pk_bf16_f32 v97, v82, v83
  v_cvt_pk_bf16_f32 v98, v84, v85
  v_cvt_pk_bf16_f32 v99, v86, v87
  v_exp_f32 v88, v88
  v_exp_f32 v89, v89
  v_exp_f32 v90, v90
  v_exp_f32 v91, v91
  v_mfma_f32_32x32x16_bf16 v[104:119], v[40:43], v[96:99], v[104:119]
  ds_read_b128 v[60:63], v5 offset:48128
  v_exp_f32 v92, v92
  v_exp_f32 v93, v93
  v_exp_f32 v94, v94
  v_exp_f32 v95, v95
  s_waitcnt lgkmcnt(4)
  v_cvt_pk_bf16_f32 v100, v88, v89
  v_cvt_pk_bf16_f32 v101, v90, v91
  v_cvt_pk_bf16_f32 v102, v92, v93
  v_cvt_pk_bf16_f32 v103, v94, v95
  v_mfma_f32_32x32x16_bf16 v[80:95], v[32:35], v[136:139], v[120:135]
  ds_read_b128 v[24:27], v5 offset:53248
  v_exp_f32 v64, v64
  v_exp_f32 v65, v65
  v_exp_f32 v66, v66
  v_exp_f32 v67, v67
  v_mfma_f32_32x32x16_bf16 v[104:119], v[44:47], v[100:103], v[104:119]
  buffer_load_dwordx4 v4, s[4:7], s33 offen offset:3072 lds
  ds_read_b128 v[28:31], v5 offset:54272
  v_exp_f32 v68, v68
  v_exp_f32 v69, v69
  v_exp_f32 v70, v70
  v_exp_f32 v71, v71
  v_mfma_f32_32x32x16_bf16 v[80:95], v[36:39], v[140:143], v[80:95]
  s_lshl_b32 s34, s56, 14
  s_add_u32 s34, s34, s55
  s_add_u32 s56, s56, 1
  s_and_b32 s56, s56, 15
  s_add_u32 m0, s31, 114688
  s_nop 0
  buffer_load_dwordx4 v4, s[4:7], s34 offen offset:0 lds
  ds_read_b128 v[40:43], v5 offset:51200
  v_cvt_pk_bf16_f32 v96, v64, v65
  v_cvt_pk_bf16_f32 v97, v66, v67
  v_cvt_pk_bf16_f32 v98, v68, v69
  v_cvt_pk_bf16_f32 v99, v70, v71
  v_exp_f32 v72, v72
  v_exp_f32 v73, v73
  v_exp_f32 v74, v74
  v_exp_f32 v75, v75
  v_mfma_f32_32x32x16_bf16 v[104:119], v[48:51], v[96:99], v[104:119]
  ds_read_b128 v[44:47], v5 offset:52224
  v_exp_f32 v76, v76
  v_exp_f32 v77, v77
  v_exp_f32 v78, v78
  v_exp_f32 v79, v79
  s_waitcnt lgkmcnt(4)
  v_cvt_pk_bf16_f32 v100, v72, v73
  v_cvt_pk_bf16_f32 v101, v74, v75
  v_cvt_pk_bf16_f32 v102, v76, v77
  v_cvt_pk_bf16_f32 v103, v78, v79
  v_mfma_f32_32x32x16_bf16 v[64:79], v[16:19], v[136:139], v[120:135]
  buffer_load_dwordx4 a[16:19], v4, s[4:7], s46 offen offset:2048
  ds_read_b128 v[32:35], v5 offset:57344
  v_exp_f32 v80, v80
  v_exp_f32 v81, v81
  v_exp_f32 v82, v82
  v_exp_f32 v83, v83
  v_mfma_f32_32x32x16_bf16 v[104:119], v[52:55], v[100:103], v[104:119]
  buffer_load_dwordx4 v4, s[4:7], s34 offen offset:1024 lds
  ds_read_b128 v[36:39], v5 offset:58368
  v_exp_f32 v84, v84
  v_exp_f32 v85, v85
  v_exp_f32 v86, v86
  v_exp_f32 v87, v87
  v_mfma_f32_32x32x16_bf16 v[64:79], v[20:23], v[140:143], v[64:79]
  buffer_load_dwordx4 v4, s[4:7], s34 offen offset:2048 lds
  ds_read_b128 v[48:51], v5 offset:55296
  v_cvt_pk_bf16_f32 v96, v80, v81
  v_cvt_pk_bf16_f32 v97, v82, v83
  v_cvt_pk_bf16_f32 v98, v84, v85
  v_cvt_pk_bf16_f32 v99, v86, v87
  v_exp_f32 v88, v88
  v_exp_f32 v89, v89
  v_exp_f32 v90, v90
  v_exp_f32 v91, v91
  v_mfma_f32_32x32x16_bf16 v[104:119], v[56:59], v[96:99], v[104:119]
  ds_read_b128 v[52:55], v5 offset:56320
  v_exp_f32 v92, v92
  v_exp_f32 v93, v93
  v_exp_f32 v94, v94
  v_exp_f32 v95, v95
  s_waitcnt lgkmcnt(4)
  v_cvt_pk_bf16_f32 v100, v88, v89
  v_cvt_pk_bf16_f32 v101, v90, v91
  v_cvt_pk_bf16_f32 v102, v92, v93
  v_cvt_pk_bf16_f32 v103, v94, v95
  v_mfma_f32_32x32x16_bf16 v[80:95], v[24:27], v[136:139], v[120:135]
  buffer_load_dwordx4 a[20:23], v4, s[4:7], s47 offen offset:2048
  ds_read_b128 v[16:19], v5 offset:61440
  v_exp_f32 v64, v64
  v_exp_f32 v65, v65
  v_exp_f32 v66, v66
  v_exp_f32 v67, v67
  v_mfma_f32_32x32x16_bf16 v[104:119], v[60:63], v[100:103], v[104:119]
  buffer_load_dwordx4 v4, s[4:7], s34 offen offset:3072 lds
  ds_read_b128 v[20:23], v5 offset:62464
  v_exp_f32 v68, v68
  v_exp_f32 v69, v69
  v_exp_f32 v70, v70
  v_exp_f32 v71, v71
  v_mfma_f32_32x32x16_bf16 v[80:95], v[28:31], v[140:143], v[80:95]
  s_lshl_b32 s33, s56, 14
  s_add_u32 s33, s33, s55
  s_add_u32 s56, s56, 1
  s_and_b32 s56, s56, 15
  s_add_u32 m0, s31, 0
  s_nop 0
  buffer_load_dwordx4 v4, s[4:7], s33 offen offset:0 lds
  ds_read_b128 v[56:59], v5 offset:59392
  v_cvt_pk_bf16_f32 v96, v64, v65
  v_cvt_pk_bf16_f32 v97, v66, v67
  v_cvt_pk_bf16_f32 v98, v68, v69
  v_cvt_pk_bf16_f32 v99, v70, v71
  v_exp_f32 v72, v72
  v_exp_f32 v73, v73
  v_exp_f32 v74, v74
  v_exp_f32 v75, v75
  v_mfma_f32_32x32x16_bf16 v[104:119], v[40:43], v[96:99], v[104:119]
  ds_read_b128 v[60:63], v5 offset:60416
  v_exp_f32 v76, v76
  v_exp_f32 v77, v77
  v_exp_f32 v78, v78
  v_exp_f32 v79, v79
  s_waitcnt lgkmcnt(4)
  v_cvt_pk_bf16_f32 v100, v72, v73
  v_cvt_pk_bf16_f32 v101, v74, v75
  v_cvt_pk_bf16_f32 v102, v76, v77
  v_cvt_pk_bf16_f32 v103, v78, v79
  v_mfma_f32_32x32x16_bf16 v[64:79], v[32:35], v[136:139], v[120:135]
  s_waitcnt vmcnt(19)
  s_barrier
  buffer_load_dwordx4 a[24:27], v4, s[4:7], s46 offen offset:3072
  ds_read_b128 v[24:27], v6 offset:0
  v_exp_f32 v80, v80
  v_exp_f32 v81, v81
  v_exp_f32 v82, v82
  v_exp_f32 v83, v83
  v_mfma_f32_32x32x16_bf16 v[104:119], v[44:47], v[100:103], v[104:119]
  buffer_load_dwordx4 v4, s[4:7], s33 offen offset:1024 lds
  ds_read_b128 v[28:31], v6 offset:1024
  v_exp_f32 v84, v84
  v_exp_f32 v85, v85
  v_exp_f32 v86, v86
  v_exp_f32 v87, v87
  v_mfma_f32_32x32x16_bf16 v[64:79], v[36:39], v[140:143], v[64:79]
  buffer_load_dwordx4 v4, s[4:7], s33 offen offset:2048 lds
  ds_read_b128 v[40:43], v5 offset:63488
  v_cvt_pk_bf16_f32 v96, v80, v81
  v_cvt_pk_bf16_f32 v97, v82, v83
  v_cvt_pk_bf16_f32 v98, v84, v85
  v_cvt_pk_bf16_f32 v99, v86, v87
  v_exp_f32 v88, v88
  v_exp_f32 v89, v89
  v_exp_f32 v90, v90
  v_exp_f32 v91, v91
  v_mfma_f32_32x32x16_bf16 v[104:119], v[48:51], v[96:99], v[104:119]
  ds_read_b128 v[44:47], v5 offset:64512
  v_exp_f32 v92, v92
  v_exp_f32 v93, v93
  v_exp_f32 v94, v94
  v_exp_f32 v95, v95
  s_waitcnt lgkmcnt(4)
  v_cvt_pk_bf16_f32 v100, v88, v89
  v_cvt_pk_bf16_f32 v101, v90, v91
  v_cvt_pk_bf16_f32 v102, v92, v93
  v_cvt_pk_bf16_f32 v103, v94, v95
  v_mfma_f32_32x32x16_bf16 v[80:95], v[16:19], v[136:139], v[120:135]
  ds_read_b128 v[32:35], v6 offset:4096
  v_exp_f32 v64, v64
  v_exp_f32 v65, v65
  v_exp_f32 v66, v66
  v_exp_f32 v67, v67
  v_mfma_f32_32x32x16_bf16 v[104:119], v[52:55], v[100:103], v[104:119]
  buffer_load_dwordx4 v4, s[4:7], s33 offen offset:3072 lds
  ds_read_b128 v[36:39], v6 offset:5120
  v_exp_f32 v68, v68
  v_exp_f32 v69, v69
  v_exp_f32 v70, v70
  v_exp_f32 v71, v71
  v_mfma_f32_32x32x16_bf16 v[80:95], v[20:23], v[140:143], v[80:95]
  s_lshl_b32 s34, s56, 14
  s_add_u32 s34, s34, s55
  s_add_u32 s56, s56, 1
  s_and_b32 s56, s56, 15
  s_add_u32 m0, s31, 16384
  s_nop 0
  buffer_load_dwordx4 v4, s[4:7], s34 offen offset:0 lds
  ds_read_b128 v[48:51], v6 offset:2048
  v_cvt_pk_bf16_f32 v96, v64, v65
  v_cvt_pk_bf16_f32 v97, v66, v67
  v_cvt_pk_bf16_f32 v98, v68, v69
  v_cvt_pk_bf16_f32 v99, v70, v71
  v_exp_f32 v72, v72
  v_exp_f32 v73, v73
  v_exp_f32 v74, v74
  v_exp_f32 v75, v75
  v_mfma_f32_32x32x16_bf16 v[104:119], v[56:59], v[96:99], v[104:119]
  ds_read_b128 v[52:55], v6 offset:3072
  v_exp_f32 v76, v76
  v_exp_f32 v77, v77
  v_exp_f32 v78, v78
  v_exp_f32 v79, v79
  s_waitcnt lgkmcnt(4)
  v_cvt_pk_bf16_f32 v100, v72, v73
  v_cvt_pk_bf16_f32 v101, v74, v75
  v_cvt_pk_bf16_f32 v102, v76, v77
  v_cvt_pk_bf16_f32 v103, v78, v79
  v_mfma_f32_32x32x16_bf16 v[64:79], v[24:27], v[136:139], v[120:135]
  buffer_load_dwordx4 a[28:31], v4, s[4:7], s47 offen offset:3072
  s_add_u32 s46, s46, 4096
  s_add_u32 s47, s47, 4096
  ds_read_b128 v[16:19], v6 offset:8192
  v_exp_f32 v80, v80
  v_exp_f32 v81, v81
  v_exp_f32 v82, v82
  v_exp_f32 v83, v83
  v_mfma_f32_32x32x16_bf16 v[104:119], v[60:63], v[100:103], v[104:119]
  buffer_load_dwordx4 v4, s[4:7], s34 offen offset:1024 lds
  ds_read_b128 v[20:23], v6 offset:9216
  v_exp_f32 v84, v84
  v_exp_f32 v85, v85
  v_exp_f32 v86, v86
  v_exp_f32 v87, v87
  v_mfma_f32_32x32x16_bf16 v[64:79], v[28:31], v[140:143], v[64:79]
  buffer_load_dwordx4 v4, s[4:7], s34 offen offset:2048 lds
  ds_read_b128 v[56:59], v6 offset:6144
  v_cvt_pk_bf16_f32 v96, v80, v81
  v_cvt_pk_bf16_f32 v97, v82, v83
  v_cvt_pk_bf16_f32 v98, v84, v85
  v_cvt_pk_bf16_f32 v99, v86, v87
  v_exp_f32 v88, v88
  v_exp_f32 v89, v89
  v_exp_f32 v90, v90
  v_exp_f32 v91, v91
  v_mfma_f32_32x32x16_bf16 v[104:119], v[40:43], v[96:99], v[104:119]
  ds_read_b128 v[60:63], v6 offset:7168
  v_exp_f32 v92, v92
  v_exp_f32 v93, v93
  v_exp_f32 v94, v94
  v_exp_f32 v95, v95
  s_waitcnt lgkmcnt(4)
  v_cvt_pk_bf16_f32 v100, v88, v89
  v_cvt_pk_bf16_f32 v101, v90, v91
  v_cvt_pk_bf16_f32 v102, v92, v93
  v_cvt_pk_bf16_f32 v103, v94, v95
  v_mfma_f32_32x32x16_bf16 v[80:95], v[32:35], v[136:139], v[120:135]
  buffer_load_dwordx4 a[32:35], v4, s[4:7], s46 offen offset:0
  ds_read_b128 v[24:27], v6 offset:12288
  v_exp_f32 v64, v64
  v_exp_f32 v65, v65
  v_exp_f32 v66, v66
  v_exp_f32 v67, v67
  v_mfma_f32_32x32x16_bf16 v[104:119], v[44:47], v[100:103], v[104:119]
  buffer_load_dwordx4 v4, s[4:7], s34 offen offset:3072 lds
  ds_read_b128 v[28:31], v6 offset:13312
  v_exp_f32 v68, v68
  v_exp_f32 v69, v69
  v_exp_f32 v70, v70
  v_exp_f32 v71, v71
  v_mfma_f32_32x32x16_bf16 v[80:95], v[36:39], v[140:143], v[80:95]
  s_lshl_b32 s33, s56, 14
  s_add_u32 s33, s33, s55
  s_add_u32 s56, s56, 1
  s_and_b32 s56, s56, 15
  s_add_u32 m0, s31, 32768
  s_nop 0
  buffer_load_dwordx4 v4, s[4:7], s33 offen offset:0 lds
  ds_read_b128 v[40:43], v6 offset:10240
  v_cvt_pk_bf16_f32 v96, v64, v65
  v_cvt_pk_bf16_f32 v97, v66, v67
  v_cvt_pk_bf16_f32 v98, v68, v69
  v_cvt_pk_bf16_f32 v99, v70, v71
  v_exp_f32 v72, v72
  v_exp_f32 v73, v73
  v_exp_f32 v74, v74
  v_exp_f32 v75, v75
  v_mfma_f32_32x32x16_bf16 v[104:119], v[48:51], v[96:99], v[104:119]
  ds_read_b128 v[44:47], v6 offset:11264
  v_exp_f32 v76, v76
  v_exp_f32 v77, v77
  v_exp_f32 v78, v78
  v_exp_f32 v79, v79
  s_waitcnt lgkmcnt(4)
  v_cvt_pk_bf16_f32 v100, v72, v73
  v_cvt_pk_bf16_f32 v101, v74, v75
  v_cvt_pk_bf16_f32 v102, v76, v77
  v_cvt_pk_bf16_f32 v103, v78, v79
  v_mfma_f32_32x32x16_bf16 v[64:79], v[16:19], v[136:139], v[120:135]
  s_waitcnt vmcnt(24)
  s_barrier
  buffer_load_dwordx4 a[36:39], v4, s[4:7], s47 offen offset:0
  ds_read_b128 v[32:35], v6 offset:16384
  v_exp_f32 v80, v80
  v_exp_f32 v81, v81
  v_exp_f32 v82, v82
  v_exp_f32 v83, v83
  v_mfma_f32_32x32x16_bf16 v[104:119], v[52:55], v[100:103], v[104:119]
  buffer_load_dwordx4 v4, s[4:7], s33 offen offset:1024 lds
  ds_read_b128 v[36:39], v6 offset:17408
  v_exp_f32 v84, v84
  v_exp_f32 v85, v85
  v_exp_f32 v86, v86
  v_exp_f32 v87, v87
  v_mfma_f32_32x32x16_bf16 v[64:79], v[20:23], v[140:143], v[64:79]
  buffer_load_dwordx4 v4, s[4:7], s33 offen offset:2048 lds
  ds_read_b128 v[48:51], v6 offset:14336
  v_cvt_pk_bf16_f32 v96, v80, v81
  v_cvt_pk_bf16_f32 v97, v82, v83
  v_cvt_pk_bf16_f32 v98, v84, v85
  v_cvt_pk_bf16_f32 v99, v86, v87
  v_exp_f32 v88, v88
  v_exp_f32 v89, v89
  v_exp_f32 v90, v90
  v_exp_f32 v91, v91
  v_mfma_f32_32x32x16_bf16 v[104:119], v[56:59], v[96:99], v[104:119]
  ds_read_b128 v[52:55], v6 offset:15360
  v_exp_f32 v92, v92
  v_exp_f32 v93, v93
  v_exp_f32 v94, v94
  v_exp_f32 v95, v95
  s_waitcnt lgkmcnt(4)
  v_cvt_pk_bf16_f32 v100, v88, v89
  v_cvt_pk_bf16_f32 v101, v90, v91
  v_cvt_pk_bf16_f32 v102, v92, v93
  v_cvt_pk_bf16_f32 v103, v94, v95
  v_mfma_f32_32x32x16_bf16 v[80:95], v[24:27], v[136:139], v[120:135]
  ds_read_b128 v[16:19], v6 offset:20480
  v_exp_f32 v64, v64
  v_exp_f32 v65, v65
  v_exp_f32 v66, v66
  v_exp_f32 v67, v67
  v_mfma_f32_32x32x16_bf16 v[104:119], v[60:63], v[100:103], v[104:119]
  buffer_load_dwordx4 v4, s[4:7], s33 offen offset:3072 lds
  ds_read_b128 v[20:23], v6 offset:21504
  v_exp_f32 v68, v68
  v_exp_f32 v69, v69
  v_exp_f32 v70, v70
  v_exp_f32 v71, v71
  v_mfma_f32_32x32x16_bf16 v[80:95], v[28:31], v[140:143], v[80:95]
  s_lshl_b32 s34, s56, 14
  s_add_u32 s34, s34, s55
  s_add_u32 s56, s56, 1
  s_and_b32 s56, s56, 15
  s_add_u32 m0, s31, 49152
  s_nop 0
  buffer_load_dwordx4 v4, s[4:7], s34 offen offset:0 lds
  ds_read_b128 v[56:59], v6 offset:18432
  v_cvt_pk_bf16_f32 v96, v64, v65
  v_cvt_pk_bf16_f32 v97, v66, v67
  v_cvt_pk_bf16_f32 v98, v68, v69
  v_cvt_pk_bf16_f32 v99, v70, v71
  v_exp_f32 v72, v72
  v_exp_f32 v73, v73
  v_exp_f32 v74, v74
  v_exp_f32 v75, v75
  v_mfma_f32_32x32x16_bf16 v[104:119], v[40:43], v[96:99], v[104:119]
  ds_read_b128 v[60:63], v6 offset:19456
  v_exp_f32 v76, v76
  v_exp_f32 v77, v77
  v_exp_f32 v78, v78
  v_exp_f32 v79, v79
  s_waitcnt lgkmcnt(4)
  v_cvt_pk_bf16_f32 v100, v72, v73
  v_cvt_pk_bf16_f32 v101, v74, v75
  v_cvt_pk_bf16_f32 v102, v76, v77
  v_cvt_pk_bf16_f32 v103, v78, v79
  v_mfma_f32_32x32x16_bf16 v[64:79], v[32:35], v[136:139], v[120:135]
  buffer_load_dwordx4 a[40:43], v4, s[4:7], s46 offen offset:1024
  ds_read_b128 v[24:27], v6 offset:24576
  v_exp_f32 v80, v80
  v_exp_f32 v81, v81
  v_exp_f32 v82, v82
  v_exp_f32 v83, v83
  v_mfma_f32_32x32x16_bf16 v[104:119], v[44:47], v[100:103], v[104:119]
  ds_read_b128 v[28:31], v6 offset:25600
  v_exp_f32 v84, v84
  v_exp_f32 v85, v85
  v_exp_f32 v86, v86
  v_exp_f32 v87, v87
  v_mfma_f32_32x32x16_bf16 v[64:79], v[36:39], v[140:143], v[64:79]
  buffer_load_dwordx4 v4, s[4:7], s34 offen offset:1024 lds
  ds_read_b128 v[40:43], v6 offset:22528
  v_cvt_pk_bf16_f32 v96, v80, v81
  v_cvt_pk_bf16_f32 v97, v82, v83
  v_cvt_pk_bf16_f32 v98, v84, v85
  v_cvt_pk_bf16_f32 v99, v86, v87
  v_exp_f32 v88, v88
  v_exp_f32 v89, v89
  v_exp_f32 v90, v90
  v_exp_f32 v91, v91
  v_mfma_f32_32x32x16_bf16 v[104:119], v[48:51], v[96:99], v[104:119]
  ds_read_b128 v[44:47], v6 offset:23552
  v_exp_f32 v92, v92
  v_exp_f32 v93, v93
  v_exp_f32 v94, v94
  v_exp_f32 v95, v95
  s_waitcnt lgkmcnt(4)
  v_cvt_pk_bf16_f32 v100, v88, v89
  v_cvt_pk_bf16_f32 v101, v90, v91
  v_cvt_pk_bf16_f32 v102, v92, v93
  v_cvt_pk_bf16_f32 v103, v94, v95
  v_mfma_f32_32x32x16_bf16 v[80:95], v[16:19], v[136:139], v[120:135]
  buffer_load_dwordx4 a[44:47], v4, s[4:7], s47 offen offset:1024
  ds_read_b128 v[32:35], v6 offset:28672
  v_exp_f32 v64, v64
  v_exp_f32 v65, v65
  v_exp_f32 v66, v66
  v_exp_f32 v67, v67
  v_mfma_f32_32x32x16_bf16 v[104:119], v[52:55], v[100:103], v[104:119]
  ds_read_b128 v[36:39], v6 offset:29696
  v_exp_f32 v68, v68
  v_exp_f32 v69, v69
  v_exp_f32 v70, v70
  v_exp_f32 v71, v71
  v_mfma_f32_32x32x16_bf16 v[80:95], v[20:23], v[140:143], v[80:95]
  buffer_load_dwordx4 v4, s[4:7], s34 offen offset:2048 lds
  ds_read_b128 v[48:51], v6 offset:26624
  v_cvt_pk_bf16_f32 v96, v64, v65
  v_cvt_pk_bf16_f32 v97, v66, v67
  v_cvt_pk_bf16_f32 v98, v68, v69
  v_cvt_pk_bf16_f32 v99, v70, v71
  v_exp_f32 v72, v72
  v_exp_f32 v73, v73
  v_exp_f32 v74, v74
  v_exp_f32 v75, v75
  v_mfma_f32_32x32x16_bf16 v[104:119], v[56:59], v[96:99], v[104:119]
  ds_read_b128 v[52:55], v6 offset:27648
  v_exp_f32 v76, v76
  v_exp_f32 v77, v77
  v_exp_f32 v78, v78
  v_exp_f32 v79, v79
  s_waitcnt lgkmcnt(4)
  v_cvt_pk_bf16_f32 v100, v72, v73
  v_cvt_pk_bf16_f32 v101, v74, v75
  v_cvt_pk_bf16_f32 v102, v76, v77
  v_cvt_pk_bf16_f32 v103, v78, v79
  v_mfma_f32_32x32x16_bf16 v[64:79], v[24:27], v[136:139], v[120:135]
  s_waitcnt vmcnt(27)
  s_barrier
  buffer_load_dwordx4 a[48:51], v4, s[4:7], s46 offen offset:2048
  ds_read_b128 v[16:19], v6 offset:32768
  v_exp_f32 v80, v80
  v_exp_f32 v81, v81
  v_exp_f32 v82, v82
  v_exp_f32 v83, v83
  v_mfma_f32_32x32x16_bf16 v[104:119], v[60:63], v[100:103], v[104:119]
  buffer_load_dwordx4 v4, s[4:7], s34 offen offset:3072 lds
  ds_read_b128 v[20:23], v6 offset:33792
  v_exp_f32 v84, v84
  v_exp_f32 v85, v85
  v_exp_f32 v86, v86
  v_exp_f32 v87, v87
  v_mfma_f32_32x32x16_bf16 v[64:79], v[28:31], v[140:143], v[64:79]
  s_lshl_b32 s33, s56, 14
  s_add_u32 s33, s33, s55
  s_add_u32 s56, s56, 1
  s_and_b32 s56, s56, 15
  s_add_u32 m0, s31, 65536
  s_nop 0
  buffer_load_dwordx4 v4, s[4:7], s33 offen offset:0 lds
  ds_read_b128 v[56:59], v6 offset:30720
  v_cvt_pk_bf16_f32 v96, v80, v81
  v_cvt_pk_bf16_f32 v97, v82, v83
  v_cvt_pk_bf16_f32 v98, v84, v85
  v_cvt_pk_bf16_f32 v99, v86, v87
  v_exp_f32 v88, v88
  v_exp_f32 v89, v89
  v_exp_f32 v90, v90
  v_exp_f32 v91, v91
  v_mfma_f32_32x32x16_bf16 v[104:119], v[40:43], v[96:99], v[104:119]
  ds_read_b128 v[60:63], v6 offset:31744
  v_exp_f32 v92, v92
  v_exp_f32 v93, v93
  v_exp_f32 v94, v94
  v_exp_f32 v95, v95
  s_waitcnt lgkmcnt(4)
  v_cvt_pk_bf16_f32 v100, v88, v89
  v_cvt_pk_bf16_f32 v101, v90, v91
  v_cvt_pk_bf16_f32 v102, v92, v93
  v_cvt_pk_bf16_f32 v103, v94, v95
  v_mfma_f32_32x32x16_bf16 v[80:95], v[32:35], v[136:139], v[120:135]
  buffer_load_dwordx4 a[52:55], v4, s[4:7], s47 offen offset:2048
  ds_read_b128 v[24:27], v6 offset:36864
  v_exp_f32 v64, v64
  v_exp_f32 v65, v65
  v_exp_f32 v66, v66
  v_exp_f32 v67, v67
  v_mfma_f32_32x32x16_bf16 v[104:119], v[44:47], v[100:103], v[104:119]
  ds_read_b128 v[28:31], v6 offset:37888
  v_exp_f32 v68, v68
  v_exp_f32 v69, v69
  v_exp_f32 v70, v70
  v_exp_f32 v71, v71
  v_mfma_f32_32x32x16_bf16 v[80:95], v[36:39], v[140:143], v[80:95]
  buffer_load_dwordx4 v4, s[4:7], s33 offen offset:1024 lds
  ds_read_b128 v[40:43], v6 offset:34816
  v_cvt_pk_bf16_f32 v96, v64, v65
  v_cvt_pk_bf16_f32 v97, v66, v67
  v_cvt_pk_bf16_f32 v98, v68, v69
  v_cvt_pk_bf16_f32 v99, v70, v71
  v_exp_f32 v72, v72
  v_exp_f32 v73, v73
  v_exp_f32 v74, v74
  v_exp_f32 v75, v75
  v_mfma_f32_32x32x16_bf16 v[104:119], v[48:51], v[96:99], v[104:119]
  ds_read_b128 v[44:47], v6 offset:35840
  v_exp_f32 v76, v76
  v_exp_f32 v77, v77
  v_exp_f32 v78, v78
  v_exp_f32 v79, v79
  s_waitcnt lgkmcnt(4)
  v_cvt_pk_bf16_f32 v100, v72, v73
  v_cvt_pk_bf16_f32 v101, v74, v75
  v_cvt_pk_bf16_f32 v102, v76, v77
  v_cvt_pk_bf16_f32 v103, v78, v79
  v_mfma_f32_32x32x16_bf16 v[64:79], v[16:19], v[136:139], v[120:135]
  ds_read_b128 v[32:35], v6 offset:40960
  v_exp_f32 v80, v80
  v_exp_f32 v81, v81
  v_exp_f32 v82, v82
  v_exp_f32 v83, v83
  v_mfma_f32_32x32x16_bf16 v[104:119], v[52:55], v[100:103], v[104:119]
  ds_read_b128 v[36:39], v6 offset:41984
  v_exp_f32 v84, v84
  v_exp_f32 v85, v85
  v_exp_f32 v86, v86
  v_exp_f32 v87, v87
  v_mfma_f32_32x32x16_bf16 v[64:79], v[20:23], v[140:143], v[64:79]
  buffer_load_dwordx4 v4, s[4:7], s33 offen offset:2048 lds
  ds_read_b128 v[48:51], v6 offset:38912
  v_cvt_pk_bf16_f32 v96, v80, v81
  v_cvt_pk_bf16_f32 v97, v82, v83
  v_cvt_pk_bf16_f32 v98, v84, v85
  v_cvt_pk_bf16_f32 v99, v86, v87
  v_exp_f32 v88, v88
  v_exp_f32 v89, v89
  v_exp_f32 v90, v90
  v_exp_f32 v91, v91
  v_mfma_f32_32x32x16_bf16 v[104:119], v[56:59], v[96:99], v[104:119]
  ds_read_b128 v[52:55], v6 offset:39936
  v_exp_f32 v92, v92
  v_exp_f32 v93, v93
  v_exp_f32 v94, v94
  v_exp_f32 v95, v95
  s_waitcnt lgkmcnt(4)
  v_cvt_pk_bf16_f32 v100, v88, v89
  v_cvt_pk_bf16_f32 v101, v90, v91
  v_cvt_pk_bf16_f32 v102, v92, v93
  v_cvt_pk_bf16_f32 v103, v94, v95
  v_mfma_f32_32x32x16_bf16 v[80:95], v[24:27], v[136:139], v[120:135]
  buffer_load_dwordx4 a[56:59], v4, s[4:7], s46 offen offset:3072
  ds_read_b128 v[16:19], v6 offset:45056
  v_exp_f32 v64, v64
  v_exp_f32 v65, v65
  v_exp_f32 v66, v66
  v_exp_f32 v67, v67
  v_mfma_f32_32x32x16_bf16 v[104:119], v[60:63], v[100:103], v[104:119]
  ds_read_b128 v[20:23], v6 offset:46080
  v_exp_f32 v68, v68
  v_exp_f32 v69, v69
  v_exp_f32 v70, v70
  v_exp_f32 v71, v71
  v_mfma_f32_32x32x16_bf16 v[80:95], v[28:31], v[140:143], v[80:95]
  buffer_load_dwordx4 v4, s[4:7], s33 offen offset:3072 lds
  ds_read_b128 v[56:59], v6 offset:43008
  v_cvt_pk_bf16_f32 v96, v64, v65
  v_cvt_pk_bf16_f32 v97, v66, v67
  v_cvt_pk_bf16_f32 v98, v68, v69
  v_cvt_pk_bf16_f32 v99, v70, v71
  v_exp_f32 v72, v72
  v_exp_f32 v73, v73
  v_exp_f32 v74, v74
  v_exp_f32 v75, v75
  v_mfma_f32_32x32x16_bf16 v[104:119], v[40:43], v[96:99], v[104:119]
  ds_read_b128 v[60:63], v6 offset:44032
  v_exp_f32 v76, v76
  v_exp_f32 v77, v77
  v_exp_f32 v78, v78
  v_exp_f32 v79, v79
  s_waitcnt lgkmcnt(4)
  v_cvt_pk_bf16_f32 v100, v72, v73
  v_cvt_pk_bf16_f32 v101, v74, v75
  v_cvt_pk_bf16_f32 v102, v76, v77
  v_cvt_pk_bf16_f32 v103, v78, v79
  v_mfma_f32_32x32x16_bf16 v[64:79], v[32:35], v[136:139], v[120:135]
  s_waitcnt vmcnt(29)
  s_barrier
  buffer_load_dwordx4 a[60:63], v4, s[4:7], s47 offen offset:3072
  s_add_u32 s46, s46, 4096
  s_add_u32 s47, s47, 4096
  ds_read_b128 v[24:27], v6 offset:49152
  v_exp_f32 v80, v80
  v_exp_f32 v81, v81
  v_exp_f32 v82, v82
  v_exp_f32 v83, v83
  v_mfma_f32_32x32x16_bf16 v[104:119], v[44:47], v[100:103], v[104:119]
  ds_read_b128 v[28:31], v6 offset:50176
  v_exp_f32 v84, v84
  v_exp_f32 v85, v85
  v_exp_f32 v86, v86
  v_exp_f32 v87, v87
  v_mfma_f32_32x32x16_bf16 v[64:79], v[36:39], v[140:143], v[64:79]
  s_lshl_b32 s34, s56, 14
  s_add_u32 s34, s34, s55
  s_add_u32 s56, s56, 1
  s_and_b32 s56, s56, 15
  s_add_u32 m0, s31, 81920
  s_nop 0
  buffer_load_dwordx4 v4, s[4:7], s34 offen offset:0 lds
  ds_read_b128 v[40:43], v6 offset:47104
  v_cvt_pk_bf16_f32 v96, v80, v81
  v_cvt_pk_bf16_f32 v97, v82, v83
  v_cvt_pk_bf16_f32 v98, v84, v85
  v_cvt_pk_bf16_f32 v99, v86, v87
  v_exp_f32 v88, v88
  v_exp_f32 v89, v89
  v_exp_f32 v90, v90
  v_exp_f32 v91, v91
  v_mfma_f32_32x32x16_bf16 v[104:119], v[48:51], v[96:99], v[104:119]
  ds_read_b128 v[44:47], v6 offset:48128
  v_exp_f32 v92, v92
  v_exp_f32 v93, v93
  v_exp_f32 v94, v94
  v_exp_f32 v95, v95
  s_waitcnt lgkmcnt(4)
  v_cvt_pk_bf16_f32 v100, v88, v89
  v_cvt_pk_bf16_f32 v101, v90, v91
  v_cvt_pk_bf16_f32 v102, v92, v93
  v_cvt_pk_bf16_f32 v103, v94, v95
  v_mfma_f32_32x32x16_bf16 v[80:95], v[16:19], v[136:139], v[120:135]
  buffer_load_dwordx4 a[64:67], v4, s[4:7], s46 offen offset:0
  ds_read_b128 v[32:35], v6 offset:53248
  v_exp_f32 v64, v64
  v_exp_f32 v65, v65
  v_exp_f32 v66, v66
  v_exp_f32 v67, v67
  v_mfma_f32_32x32x16_bf16 v[104:119], v[52:55], v[100:103], v[104:119]
  ds_read_b128 v[36:39], v6 offset:54272
  v_exp_f32 v68, v68
  v_exp_f32 v69, v69
  v_exp_f32 v70, v70
  v_exp_f32 v71, v71
  v_mfma_f32_32x32x16_bf16 v[80:95], v[20:23], v[140:143], v[80:95]
  buffer_load_dwordx4 v4, s[4:7], s34 offen offset:1024 lds
  ds_read_b128 v[48:51], v6 offset:51200
  v_cvt_pk_bf16_f32 v96, v64, v65
  v_cvt_pk_bf16_f32 v97, v66, v67
  v_cvt_pk_bf16_f32 v98, v68, v69
  v_cvt_pk_bf16_f32 v99, v70, v71
  v_exp_f32 v72, v72
  v_exp_f32 v73, v73
  v_exp_f32 v74, v74
  v_exp_f32 v75, v75
  v_mfma_f32_32x32x16_bf16 v[104:119], v[56:59], v[96:99], v[104:119]
  ds_read_b128 v[52:55], v6 offset:52224
  v_exp_f32 v76, v76
  v_exp_f32 v77, v77
  v_exp_f32 v78, v78
  v_exp_f32 v79, v79
  s_waitcnt lgkmcnt(4)
  v_cvt_pk_bf16_f32 v100, v72, v73
  v_cvt_pk_bf16_f32 v101, v74, v75
  v_cvt_pk_bf16_f32 v102, v76, v77
  v_cvt_pk_bf16_f32 v103, v78, v79
  v_mfma_f32_32x32x16_bf16 v[64:79], v[24:27], v[136:139], v[120:135]
  ds_read_b128 v[16:19], v6 offset:57344
  v_exp_f32 v80, v80
  v_exp_f32 v81, v81
  v_exp_f32 v82, v82
  v_exp_f32 v83, v83
  v_mfma_f32_32x32x16_bf16 v[104:119], v[60:63], v[100:103], v[104:119]
  ds_read_b128 v[20:23], v6 offset:58368
  v_exp_f32 v84, v84
  v_exp_f32 v85, v85
  v_exp_f32 v86, v86
  v_exp_f32 v87, v87
  v_mfma_f32_32x32x16_bf16 v[64:79], v[28:31], v[140:143], v[64:79]
  buffer_load_dwordx4 v4, s[4:7], s34 offen offset:2048 lds
  ds_read_b128 v[56:59], v6 offset:55296
  v_cvt_pk_bf16_f32 v96, v80, v81
  v_cvt_pk_bf16_f32 v97, v82, v83
  v_cvt_pk_bf16_f32 v98, v84, v85
  v_cvt_pk_bf16_f32 v99, v86, v87
  v_exp_f32 v88, v88
  v_exp_f32 v89, v89
  v_exp_f32 v90, v90
  v_exp_f32 v91, v91
  v_mfma_f32_32x32x16_bf16 v[104:119], v[40:43], v[96:99], v[104:119]
  ds_read_b128 v[60:63], v6 offset:56320
  v_exp_f32 v92, v92
  v_exp_f32 v93, v93
  v_exp_f32 v94, v94
  v_exp_f32 v95, v95
  s_waitcnt lgkmcnt(4)
  v_cvt_pk_bf16_f32 v100, v88, v89
  v_cvt_pk_bf16_f32 v101, v90, v91
  v_cvt_pk_bf16_f32 v102, v92, v93
  v_cvt_pk_bf16_f32 v103, v94, v95
  v_mfma_f32_32x32x16_bf16 v[80:95], v[32:35], v[136:139], v[120:135]
  buffer_load_dwordx4 a[68:71], v4, s[4:7], s47 offen offset:0
  ds_read_b128 v[24:27], v6 offset:61440
  v_exp_f32 v64, v64
  v_exp_f32 v65, v65
  v_exp_f32 v66, v66
  v_exp_f32 v67, v67
  v_mfma_f32_32x32x16_bf16 v[104:119], v[44:47], v[100:103], v[104:119]
  ds_read_b128 v[28:31], v6 offset:62464
  v_exp_f32 v68, v68
  v_exp_f32 v69, v69
  v_exp_f32 v70, v70
  v_exp_f32 v71, v71
  v_mfma_f32_32x32x16_bf16 v[80:95], v[36:39], v[140:143], v[80:95]
  buffer_load_dwordx4 v4, s[4:7], s34 offen offset:3072 lds
  ds_read_b128 v[40:43], v6 offset:59392
  v_cvt_pk_bf16_f32 v96, v64, v65
  v_cvt_pk_bf16_f32 v97, v66, v67
  v_cvt_pk_bf16_f32 v98, v68, v69
  v_cvt_pk_bf16_f32 v99, v70, v71
  v_exp_f32 v72, v72
  v_exp_f32 v73, v73
  v_exp_f32 v74, v74
  v_exp_f32 v75, v75
  v_mfma_f32_32x32x16_bf16 v[104:119], v[48:51], v[96:99], v[104:119]
  ds_read_b128 v[44:47], v6 offset:60416
  v_exp_f32 v76, v76
  v_exp_f32 v77, v77
  v_exp_f32 v78, v78
  v_exp_f32 v79, v79
  s_waitcnt lgkmcnt(4)
  v_cvt_pk_bf16_f32 v100, v72, v73
  v_cvt_pk_bf16_f32 v101, v74, v75
  v_cvt_pk_bf16_f32 v102, v76, v77
  v_cvt_pk_bf16_f32 v103, v78, v79
  v_mfma_f32_32x32x16_bf16 v[64:79], v[16:19], v[136:139], v[120:135]
  s_waitcnt vmcnt(31)
  s_barrier
  buffer_load_dwordx4 a[72:75], v4, s[4:7], s46 offen offset:1024
  ds_read_b128 v[32:35], v5 offset:0
  v_exp_f32 v80, v80
  v_exp_f32 v81, v81
  v_exp_f32 v82, v82
  v_exp_f32 v83, v83
  v_mfma_f32_32x32x16_bf16 v[104:119], v[52:55], v[100:103], v[104:119]
  ds_read_b128 v[36:39], v5 offset:1024
  v_exp_f32 v84, v84
  v_exp_f32 v85, v85
  v_exp_f32 v86, v86
  v_exp_f32 v87, v87
  v_mfma_f32_32x32x16_bf16 v[64:79], v[20:23], v[140:143], v[64:79]
  s_lshl_b32 s33, s56, 14
  s_add_u32 s33, s33, s55
  s_add_u32 s56, s56, 1
  s_and_b32 s56, s56, 15
  s_add_u32 m0, s31, 98304
  s_nop 0
  buffer_load_dwordx4 v4, s[4:7], s33 offen offset:0 lds
  ds_read_b128 v[48:51], v6 offset:63488
  v_cvt_pk_bf16_f32 v96, v80, v81
  v_cvt_pk_bf16_f32 v97, v82, v83
  v_cvt_pk_bf16_f32 v98, v84, v85
  v_cvt_pk_bf16_f32 v99, v86, v87
  v_exp_f32 v88, v88
  v_exp_f32 v89, v89
  v_exp_f32 v90, v90
  v_exp_f32 v91, v91
  v_mfma_f32_32x32x16_bf16 v[104:119], v[56:59], v[96:99], v[104:119]
  ds_read_b128 v[52:55], v6 offset:64512
  v_exp_f32 v92, v92
  v_exp_f32 v93, v93
  v_exp_f32 v94, v94
  v_exp_f32 v95, v95
  s_waitcnt lgkmcnt(4)
  v_cvt_pk_bf16_f32 v100, v88, v89
  v_cvt_pk_bf16_f32 v101, v90, v91
  v_cvt_pk_bf16_f32 v102, v92, v93
  v_cvt_pk_bf16_f32 v103, v94, v95
  v_mfma_f32_32x32x16_bf16 v[80:95], v[24:27], v[136:139], v[120:135]
  buffer_load_dwordx4 a[76:79], v4, s[4:7], s47 offen offset:1024
  s_lshl_b32 s48, s26, 5
  s_lshl_b32 s49, s27, 1
  s_add_u32 s48, s48, s49
  s_lshl_b32 s48, s48, 10
  s_add_u32 s48, s48, s20
  buffer_load_dword v1, v13, s[4:7], s48 offen sc1
  ds_read_b128 v[16:19], v5 offset:4096
  v_exp_f32 v64, v64
  v_exp_f32 v65, v65
  v_exp_f32 v66, v66
  v_exp_f32 v67, v67
  v_mfma_f32_32x32x16_bf16 v[104:119], v[60:63], v[100:103], v[104:119]
  ds_read_b128 v[20:23], v5 offset:5120
  v_exp_f32 v68, v68
  v_exp_f32 v69, v69
  v_exp_f32 v70, v70
  v_exp_f32 v71, v71
  v_mfma_f32_32x32x16_bf16 v[80:95], v[28:31], v[140:143], v[80:95]
  buffer_load_dwordx4 v4, s[4:7], s33 offen offset:1024 lds
  ds_read_b128 v[56:59], v5 offset:2048
  v_cvt_pk_bf16_f32 v96, v64, v65
  v_cvt_pk_bf16_f32 v97, v66, v67
  v_cvt_pk_bf16_f32 v98, v68, v69
  v_cvt_pk_bf16_f32 v99, v70, v71
  v_exp_f32 v72, v72
  v_exp_f32 v73, v73
  v_exp_f32 v74, v74
  v_exp_f32 v75, v75
  v_mfma_f32_32x32x16_bf16 v[104:119], v[40:43], v[96:99], v[104:119]
  ds_read_b128 v[60:63], v5 offset:3072
  v_exp_f32 v76, v76
  v_exp_f32 v77, v77
  v_exp_f32 v78, v78
  v_exp_f32 v79, v79
  s_waitcnt lgkmcnt(4)
  v_cvt_pk_bf16_f32 v100, v72, v73
  v_cvt_pk_bf16_f32 v101, v74, v75
  v_cvt_pk_bf16_f32 v102, v76, v77
  v_cvt_pk_bf16_f32 v103, v78, v79
  v_mfma_f32_32x32x16_bf16 v[64:79], v[32:35], v[136:139], v[120:135]
  ds_read_b128 v[24:27], v5 offset:8192
  v_exp_f32 v80, v80
  v_exp_f32 v81, v81
  v_exp_f32 v82, v82
  v_exp_f32 v83, v83
  v_mfma_f32_32x32x16_bf16 v[104:119], v[44:47], v[100:103], v[104:119]
  ds_read_b128 v[28:31], v5 offset:9216
  v_exp_f32 v84, v84
  v_exp_f32 v85, v85
  v_exp_f32 v86, v86
  v_exp_f32 v87, v87
  v_mfma_f32_32x32x16_bf16 v[64:79], v[36:39], v[140:143], v[64:79]
  buffer_load_dwordx4 v4, s[4:7], s33 offen offset:2048 lds
  ds_read_b128 v[40:43], v5 offset:6144
  v_cvt_pk_bf16_f32 v96, v80, v81
  v_cvt_pk_bf16_f32 v97, v82, v83
  v_cvt_pk_bf16_f32 v98, v84, v85
  v_cvt_pk_bf16_f32 v99, v86, v87
  v_exp_f32 v88, v88
  v_exp_f32 v89, v89
  v_exp_f32 v90, v90
  v_exp_f32 v91, v91
  v_mfma_f32_32x32x16_bf16 v[104:119], v[48:51], v[96:99], v[104:119]
  ds_read_b128 v[44:47], v5 offset:7168
  v_exp_f32 v92, v92
  v_exp_f32 v93, v93
  v_exp_f32 v94, v94
  v_exp_f32 v95, v95
  s_waitcnt lgkmcnt(4)
  v_cvt_pk_bf16_f32 v100, v88, v89
  v_cvt_pk_bf16_f32 v101, v90, v91
  v_cvt_pk_bf16_f32 v102, v92, v93
  v_cvt_pk_bf16_f32 v103, v94, v95
  v_mfma_f32_32x32x16_bf16 v[80:95], v[16:19], v[136:139], v[120:135]
  buffer_load_dwordx4 a[80:83], v4, s[4:7], s46 offen offset:2048
  ds_read_b128 v[32:35], v5 offset:12288
  v_exp_f32 v64, v64
  v_exp_f32 v65, v65
  v_exp_f32 v66, v66
  v_exp_f32 v67, v67
  v_mfma_f32_32x32x16_bf16 v[104:119], v[52:55], v[100:103], v[104:119]
  ds_read_b128 v[36:39], v5 offset:13312
  v_exp_f32 v68, v68
  v_exp_f32 v69, v69
  v_exp_f32 v70, v70
  v_exp_f32 v71, v71
  v_mfma_f32_32x32x16_bf16 v[80:95], v[20:23], v[140:143], v[80:95]
  buffer_load_dwordx4 v4, s[4:7], s33 offen offset:3072 lds
  ds_read_b128 v[48:51], v5 offset:10240
  v_cvt_pk_bf16_f32 v96, v64, v65
  v_cvt_pk_bf16_f32 v97, v66, v67
  v_cvt_pk_bf16_f32 v98, v68, v69
  v_cvt_pk_bf16_f32 v99, v70, v71
  v_exp_f32 v72, v72
  v_exp_f32 v73, v73
  v_exp_f32 v74, v74
  v_exp_f32 v75, v75
  v_mfma_f32_32x32x16_bf16 v[104:119], v[56:59], v[96:99], v[104:119]
  ds_read_b128 v[52:55], v5 offset:11264
  v_exp_f32 v76, v76
  v_exp_f32 v77, v77
  v_exp_f32 v78, v78
  v_exp_f32 v79, v79
  s_waitcnt lgkmcnt(4)
  v_cvt_pk_bf16_f32 v100, v72, v73
  v_cvt_pk_bf16_f32 v101, v74, v75
  v_cvt_pk_bf16_f32 v102, v76, v77
  v_cvt_pk_bf16_f32 v103, v78, v79
  v_mfma_f32_32x32x16_bf16 v[64:79], v[24:27], v[136:139], v[120:135]
  s_waitcnt vmcnt(33)
  s_barrier
  buffer_load_dwordx4 a[84:87], v4, s[4:7], s47 offen offset:2048
  ds_read_b128 v[16:19], v5 offset:16384
  v_exp_f32 v80, v80
  v_exp_f32 v81, v81
  v_exp_f32 v82, v82
  v_exp_f32 v83, v83
  v_mfma_f32_32x32x16_bf16 v[104:119], v[60:63], v[100:103], v[104:119]
  ds_read_b128 v[20:23], v5 offset:17408
  v_exp_f32 v84, v84
  v_exp_f32 v85, v85
  v_exp_f32 v86, v86
  v_exp_f32 v87, v87
  v_mfma_f32_32x32x16_bf16 v[64:79], v[28:31], v[140:143], v[64:79]
  s_lshl_b32 s34, s56, 14
  s_add_u32 s34, s34, s55
  s_add_u32 s56, s56, 1
  s_and_b32 s56, s56, 15
  s_add_u32 m0, s31, 114688
  s_nop 0
  buffer_load_dwordx4 v4, s[4:7], s34 offen offset:0 lds
  ds_read_b128 v[56:59], v5 offset:14336
  v_cvt_pk_bf16_f32 v96, v80, v81
  v_cvt_pk_bf16_f32 v97, v82, v83
  v_cvt_pk_bf16_f32 v98, v84, v85
  v_cvt_pk_bf16_f32 v99, v86, v87
  v_exp_f32 v88, v88
  v_exp_f32 v89, v89
  v_exp_f32 v90, v90
  v_exp_f32 v91, v91
  v_mfma_f32_32x32x16_bf16 v[104:119], v[40:43], v[96:99], v[104:119]
  ds_read_b128 v[60:63], v5 offset:15360
  v_exp_f32 v92, v92
  v_exp_f32 v93, v93
  v_exp_f32 v94, v94
  v_exp_f32 v95, v95
  s_waitcnt lgkmcnt(4)
  v_cvt_pk_bf16_f32 v100, v88, v89
  v_cvt_pk_bf16_f32 v101, v90, v91
  v_cvt_pk_bf16_f32 v102, v92, v93
  v_cvt_pk_bf16_f32 v103, v94, v95
  v_mfma_f32_32x32x16_bf16 v[80:95], v[32:35], v[136:139], v[120:135]
  buffer_load_dwordx4 a[88:91], v4, s[4:7], s46 offen offset:3072
  s_add_u32 s48, s37, s21
  buffer_load_dword v1, v13, s[4:7], s48 offen sc1
  ds_read_b128 v[24:27], v5 offset:20480
  v_exp_f32 v64, v64
  v_exp_f32 v65, v65
  v_exp_f32 v66, v66
  v_exp_f32 v67, v67
  v_mfma_f32_32x32x16_bf16 v[104:119], v[44:47], v[100:103], v[104:119]
  ds_read_b128 v[28:31], v5 offset:21504
  v_exp_f32 v68, v68
  v_exp_f32 v69, v69
  v_exp_f32 v70, v70
  v_exp_f32 v71, v71
  v_mfma_f32_32x32x16_bf16 v[80:95], v[36:39], v[140:143], v[80:95]
  buffer_load_dwordx4 v4, s[4:7], s34 offen offset:1024 lds
  ds_read_b128 v[40:43], v5 offset:18432
  v_cvt_pk_bf16_f32 v96, v64, v65
  v_cvt_pk_bf16_f32 v97, v66, v67
  v_cvt_pk_bf16_f32 v98, v68, v69
  v_cvt_pk_bf16_f32 v99, v70, v71
  v_exp_f32 v72, v72
  v_exp_f32 v73, v73
  v_exp_f32 v74, v74
  v_exp_f32 v75, v75
  v_mfma_f32_32x32x16_bf16 v[104:119], v[48:51], v[96:99], v[104:119]
  ds_read_b128 v[44:47], v5 offset:19456
  v_exp_f32 v76, v76
  v_exp_f32 v77, v77
  v_exp_f32 v78, v78
  v_exp_f32 v79, v79
  s_waitcnt lgkmcnt(4)
  v_cvt_pk_bf16_f32 v100, v72, v73
  v_cvt_pk_bf16_f32 v101, v74, v75
  v_cvt_pk_bf16_f32 v102, v76, v77
  v_cvt_pk_bf16_f32 v103, v78, v79
  v_mfma_f32_32x32x16_bf16 v[64:79], v[16:19], v[136:139], v[120:135]
  buffer_load_dwordx4 a[92:95], v4, s[4:7], s47 offen offset:3072
  s_add_u32 s46, s46, 4096
  s_add_u32 s47, s47, 4096
  ds_read_b128 v[32:35], v5 offset:24576
  v_exp_f32 v80, v80
  v_exp_f32 v81, v81
  v_exp_f32 v82, v82
  v_exp_f32 v83, v83
  v_mfma_f32_32x32x16_bf16 v[104:119], v[52:55], v[100:103], v[104:119]
  ds_read_b128 v[36:39], v5 offset:25600
  v_exp_f32 v84, v84
  v_exp_f32 v85, v85
  v_exp_f32 v86, v86
  v_exp_f32 v87, v87
  v_mfma_f32_32x32x16_bf16 v[64:79], v[20:23], v[140:143], v[64:79]
  buffer_load_dwordx4 v4, s[4:7], s34 offen offset:2048 lds
  ds_read_b128 v[48:51], v5 offset:22528
  v_cvt_pk_bf16_f32 v96, v80, v81
  v_cvt_pk_bf16_f32 v97, v82, v83
  v_cvt_pk_bf16_f32 v98, v84, v85
  v_cvt_pk_bf16_f32 v99, v86, v87
  v_exp_f32 v88, v88
  v_exp_f32 v89, v89
  v_exp_f32 v90, v90
  v_exp_f32 v91, v91
  v_mfma_f32_32x32x16_bf16 v[104:119], v[56:59], v[96:99], v[104:119]
  ds_read_b128 v[52:55], v5 offset:23552
  v_exp_f32 v92, v92
  v_exp_f32 v93, v93
  v_exp_f32 v94, v94
  v_exp_f32 v95, v95
  s_waitcnt lgkmcnt(4)
  v_cvt_pk_bf16_f32 v100, v88, v89
  v_cvt_pk_bf16_f32 v101, v90, v91
  v_cvt_pk_bf16_f32 v102, v92, v93
  v_cvt_pk_bf16_f32 v103, v94, v95
  v_mfma_f32_32x32x16_bf16 v[80:95], v[24:27], v[136:139], v[120:135]
  ds_read_b128 v[16:19], v5 offset:28672
  v_exp_f32 v64, v64
  v_exp_f32 v65, v65
  v_exp_f32 v66, v66
  v_exp_f32 v67, v67
  v_mfma_f32_32x32x16_bf16 v[104:119], v[60:63], v[100:103], v[104:119]
  ds_read_b128 v[20:23], v5 offset:29696
  v_exp_f32 v68, v68
  v_exp_f32 v69, v69
  v_exp_f32 v70, v70
  v_exp_f32 v71, v71
  v_mfma_f32_32x32x16_bf16 v[80:95], v[28:31], v[140:143], v[80:95]
  buffer_load_dwordx4 v4, s[4:7], s34 offen offset:3072 lds
  ds_read_b128 v[56:59], v5 offset:26624
  v_cvt_pk_bf16_f32 v96, v64, v65
  v_cvt_pk_bf16_f32 v97, v66, v67
  v_cvt_pk_bf16_f32 v98, v68, v69
  v_cvt_pk_bf16_f32 v99, v70, v71
  v_exp_f32 v72, v72
  v_exp_f32 v73, v73
  v_exp_f32 v74, v74
  v_exp_f32 v75, v75
  v_mfma_f32_32x32x16_bf16 v[104:119], v[40:43], v[96:99], v[104:119]
  ds_read_b128 v[60:63], v5 offset:27648
  v_exp_f32 v76, v76
  v_exp_f32 v77, v77
  v_exp_f32 v78, v78
  v_exp_f32 v79, v79
  s_waitcnt lgkmcnt(4)
  v_cvt_pk_bf16_f32 v100, v72, v73
  v_cvt_pk_bf16_f32 v101, v74, v75
  v_cvt_pk_bf16_f32 v102, v76, v77
  v_cvt_pk_bf16_f32 v103, v78, v79
  v_mfma_f32_32x32x16_bf16 v[64:79], v[32:35], v[136:139], v[120:135]
  s_waitcnt vmcnt(36)
  s_barrier
  buffer_load_dwordx4 a[96:99], v4, s[4:7], s46 offen offset:0
  ds_read_b128 v[24:27], v5 offset:32768
  v_exp_f32 v80, v80
  v_exp_f32 v81, v81
  v_exp_f32 v82, v82
  v_exp_f32 v83, v83
  v_mfma_f32_32x32x16_bf16 v[104:119], v[44:47], v[100:103], v[104:119]
  ds_read_b128 v[28:31], v5 offset:33792
  v_exp_f32 v84, v84
  v_exp_f32 v85, v85
  v_exp_f32 v86, v86
  v_exp_f32 v87, v87
  v_mfma_f32_32x32x16_bf16 v[64:79], v[36:39], v[140:143], v[64:79]
  s_mul_i32 s30, s27, 114688
  s_add_u32 s30, s30, s31
  s_add_u32 s30, s30, 0x1c0000
  s_mov_b32 s33, s30
  s_add_u32 s30, s30, 16384
  s_add_u32 m0, s31, 0
  s_nop 0
  buffer_load_dwordx4 v4, s[4:7], s33 offen offset:0 lds
  ds_read_b128 v[40:43], v5 offset:30720
  v_cvt_pk_bf16_f32 v96, v80, v81
  v_cvt_pk_bf16_f32 v97, v82, v83
  v_cvt_pk_bf16_f32 v98, v84, v85
  v_cvt_pk_bf16_f32 v99, v86, v87
  v_exp_f32 v88, v88
  v_exp_f32 v89, v89
  v_exp_f32 v90, v90
  v_exp_f32 v91, v91
  v_mfma_f32_32x32x16_bf16 v[104:119], v[48:51], v[96:99], v[104:119]
  ds_read_b128 v[44:47], v5 offset:31744
  v_exp_f32 v92, v92
  v_exp_f32 v93, v93
  v_exp_f32 v94, v94
  v_exp_f32 v95, v95
  s_waitcnt lgkmcnt(4)
  v_cvt_pk_bf16_f32 v100, v88, v89
  v_cvt_pk_bf16_f32 v101, v90, v91
  v_cvt_pk_bf16_f32 v102, v92, v93
  v_cvt_pk_bf16_f32 v103, v94, v95
  v_mfma_f32_32x32x16_bf16 v[80:95], v[16:19], v[136:139], v[120:135]
  buffer_load_dwordx4 a[100:103], v4, s[4:7], s47 offen offset:0
  s_add_u32 s48, s37, s24
  buffer_load_dword v1, v13, s[4:7], s48 offen sc1
  ds_read_b128 v[32:35], v5 offset:36864
  v_exp_f32 v64, v64
  v_exp_f32 v65, v65
  v_exp_f32 v66, v66
  v_exp_f32 v67, v67
  v_mfma_f32_32x32x16_bf16 v[104:119], v[52:55], v[100:103], v[104:119]
  ds_read_b128 v[36:39], v5 offset:37888
  v_exp_f32 v68, v68
  v_exp_f32 v69, v69
  v_exp_f32 v70, v70
  v_exp_f32 v71, v71
  v_mfma_f32_32x32x16_bf16 v[80:95], v[20:23], v[140:143], v[80:95]
  buffer_load_dwordx4 v4, s[4:7], s33 offen offset:1024 lds
  ds_read_b128 v[48:51], v5 offset:34816
  v_cvt_pk_bf16_f32 v96, v64, v65
  v_cvt_pk_bf16_f32 v97, v66, v67
  v_cvt_pk_bf16_f32 v98, v68, v69
  v_cvt_pk_bf16_f32 v99, v70, v71
  v_exp_f32 v72, v72
  v_exp_f32 v73, v73
  v_exp_f32 v74, v74
  v_exp_f32 v75, v75
  v_mfma_f32_32x32x16_bf16 v[104:119], v[56:59], v[96:99], v[104:119]
  ds_read_b128 v[52:55], v5 offset:35840
  v_exp_f32 v76, v76
  v_exp_f32 v77, v77
  v_exp_f32 v78, v78
  v_exp_f32 v79, v79
  s_waitcnt lgkmcnt(4)
  v_cvt_pk_bf16_f32 v100, v72, v73
  v_cvt_pk_bf16_f32 v101, v74, v75
  v_cvt_pk_bf16_f32 v102, v76, v77
  v_cvt_pk_bf16_f32 v103, v78, v79
  v_mfma_f32_32x32x16_bf16 v[64:79], v[24:27], v[136:139], v[120:135]
  buffer_load_dwordx4 a[104:107], v4, s[4:7], s46 offen offset:1024
  ds_read_b128 v[16:19], v5 offset:40960
  v_exp_f32 v80, v80
  v_exp_f32 v81, v81
  v_exp_f32 v82, v82
  v_exp_f32 v83, v83
  v_mfma_f32_32x32x16_bf16 v[104:119], v[60:63], v[100:103], v[104:119]
  ds_read_b128 v[20:23], v5 offset:41984
  v_exp_f32 v84, v84
  v_exp_f32 v85, v85
  v_exp_f32 v86, v86
  v_exp_f32 v87, v87
  v_mfma_f32_32x32x16_bf16 v[64:79], v[28:31], v[140:143], v[64:79]
  buffer_load_dwordx4 v4, s[4:7], s33 offen offset:2048 lds
  ds_read_b128 v[56:59], v5 offset:38912
  v_cvt_pk_bf16_f32 v96, v80, v81
  v_cvt_pk_bf16_f32 v97, v82, v83
  v_cvt_pk_bf16_f32 v98, v84, v85
  v_cvt_pk_bf16_f32 v99, v86, v87
  v_exp_f32 v88, v88
  v_exp_f32 v89, v89
  v_exp_f32 v90, v90
  v_exp_f32 v91, v91
  v_mfma_f32_32x32x16_bf16 v[104:119], v[40:43], v[96:99], v[104:119]
  ds_read_b128 v[60:63], v5 offset:39936
  v_exp_f32 v92, v92
  v_exp_f32 v93, v93
  v_exp_f32 v94, v94
  v_exp_f32 v95, v95
  s_waitcnt lgkmcnt(4)
  v_cvt_pk_bf16_f32 v100, v88, v89
  v_cvt_pk_bf16_f32 v101, v90, v91
  v_cvt_pk_bf16_f32 v102, v92, v93
  v_cvt_pk_bf16_f32 v103, v94, v95
  v_mfma_f32_32x32x16_bf16 v[80:95], v[32:35], v[136:139], v[120:135]
  ds_read_b128 v[24:27], v5 offset:45056
  v_exp_f32 v64, v64
  v_exp_f32 v65, v65
  v_exp_f32 v66, v66
  v_exp_f32 v67, v67
  v_mfma_f32_32x32x16_bf16 v[104:119], v[44:47], v[100:103], v[104:119]
  ds_read_b128 v[28:31], v5 offset:46080
  v_exp_f32 v68, v68
  v_exp_f32 v69, v69
  v_exp_f32 v70, v70
  v_exp_f32 v71, v71
  v_mfma_f32_32x32x16_bf16 v[80:95], v[36:39], v[140:143], v[80:95]
  buffer_load_dwordx4 v4, s[4:7], s33 offen offset:3072 lds
  ds_read_b128 v[40:43], v5 offset:43008
  v_cvt_pk_bf16_f32 v96, v64, v65
  v_cvt_pk_bf16_f32 v97, v66, v67
  v_cvt_pk_bf16_f32 v98, v68, v69
  v_cvt_pk_bf16_f32 v99, v70, v71
  v_exp_f32 v72, v72
  v_exp_f32 v73, v73
  v_exp_f32 v74, v74
  v_exp_f32 v75, v75
  v_mfma_f32_32x32x16_bf16 v[104:119], v[48:51], v[96:99], v[104:119]
  ds_read_b128 v[44:47], v5 offset:44032
  v_exp_f32 v76, v76
  v_exp_f32 v77, v77
  v_exp_f32 v78, v78
  v_exp_f32 v79, v79
  s_waitcnt lgkmcnt(4)
  v_cvt_pk_bf16_f32 v100, v72, v73
  v_cvt_pk_bf16_f32 v101, v74, v75
  v_cvt_pk_bf16_f32 v102, v76, v77
  v_cvt_pk_bf16_f32 v103, v78, v79
  v_mfma_f32_32x32x16_bf16 v[64:79], v[16:19], v[136:139], v[120:135]
  s_waitcnt vmcnt(37)
  s_barrier
  buffer_load_dwordx4 a[108:111], v4, s[4:7], s47 offen offset:1024
  ds_read_b128 v[32:35], v5 offset:49152
  v_exp_f32 v80, v80
  v_exp_f32 v81, v81
  v_exp_f32 v82, v82
  v_exp_f32 v83, v83
  v_mfma_f32_32x32x16_bf16 v[104:119], v[52:55], v[100:103], v[104:119]
  ds_read_b128 v[36:39], v5 offset:50176
  v_exp_f32 v84, v84
  v_exp_f32 v85, v85
  v_exp_f32 v86, v86
  v_exp_f32 v87, v87
  v_mfma_f32_32x32x16_bf16 v[64:79], v[20:23], v[140:143], v[64:79]
  s_mov_b32 s34, s30
  s_add_u32 s30, s30, 16384
  s_add_u32 m0, s31, 16384
  s_nop 0
  buffer_load_dwordx4 v4, s[4:7], s34 offen offset:0 lds
  ds_read_b128 v[48:51], v5 offset:47104
  v_cvt_pk_bf16_f32 v96, v80, v81
  v_cvt_pk_bf16_f32 v97, v82, v83
  v_cvt_pk_bf16_f32 v98, v84, v85
  v_cvt_pk_bf16_f32 v99, v86, v87
  v_exp_f32 v88, v88
  v_exp_f32 v89, v89
  v_exp_f32 v90, v90
  v_exp_f32 v91, v91
  v_mfma_f32_32x32x16_bf16 v[104:119], v[56:59], v[96:99], v[104:119]
  ds_read_b128 v[52:55], v5 offset:48128
  v_exp_f32 v92, v92
  v_exp_f32 v93, v93
  v_exp_f32 v94, v94
  v_exp_f32 v95, v95
  s_waitcnt lgkmcnt(4)
  v_cvt_pk_bf16_f32 v100, v88, v89
  v_cvt_pk_bf16_f32 v101, v90, v91
  v_cvt_pk_bf16_f32 v102, v92, v93
  v_cvt_pk_bf16_f32 v103, v94, v95
  v_mfma_f32_32x32x16_bf16 v[80:95], v[24:27], v[136:139], v[120:135]
  buffer_load_dwordx4 a[112:115], v4, s[4:7], s46 offen offset:2048
  s_lshl_b32 s48, s36, 14
  s_lshl_b32 s49, s35, 8
  s_add_u32 s48, s48, s49
  s_add_u32 s49, s48, s25
  s_add_u32 s48, s48, s22
  v_and_b32 v11, 1, v0
  v_lshlrev_b32 v11, 7, v11
  buffer_load_dword v1, v11, s[4:7], s49 offen sc1
  buffer_load_dword v1, v11, s[4:7], s48 offen sc1
  ds_read_b128 v[16:19], v5 offset:53248
  v_exp_f32 v64, v64
  v_exp_f32 v65, v65
  v_exp_f32 v66, v66
  v_exp_f32 v67, v67
  v_mfma_f32_32x32x16_bf16 v[104:119], v[60:63], v[100:103], v[104:119]
  ds_read_b128 v[20:23], v5 offset:54272
  v_exp_f32 v68, v68
  v_exp_f32 v69, v69
  v_exp_f32 v70, v70
  v_exp_f32 v71, v71
  v_mfma_f32_32x32x16_bf16 v[80:95], v[28:31], v[140:143], v[80:95]
  buffer_load_dwordx4 v4, s[4:7], s34 offen offset:1024 lds
  ds_read_b128 v[56:59], v5 offset:51200
  v_cvt_pk_bf16_f32 v96, v64, v65
  v_cvt_pk_bf16_f32 v97, v66, v67
  v_cvt_pk_bf16_f32 v98, v68, v69
  v_cvt_pk_bf16_f32 v99, v70, v71
  v_exp_f32 v72, v72
  v_exp_f32 v73, v73
  v_exp_f32 v74, v74
  v_exp_f32 v75, v75
  v_mfma_f32_32x32x16_bf16 v[104:119], v[40:43], v[96:99], v[104:119]
  ds_read_b128 v[60:63], v5 offset:52224
  v_exp_f32 v76, v76
  v_exp_f32 v77, v77
  v_exp_f32 v78, v78
  v_exp_f32 v79, v79
  s_waitcnt lgkmcnt(4)
  v_cvt_pk_bf16_f32 v100, v72, v73
  v_cvt_pk_bf16_f32 v101, v74, v75
  v_cvt_pk_bf16_f32 v102, v76, v77
  v_cvt_pk_bf16_f32 v103, v78, v79
  v_mfma_f32_32x32x16_bf16 v[64:79], v[32:35], v[136:139], v[120:135]
  buffer_load_dwordx4 a[116:119], v4, s[4:7], s47 offen offset:2048
  ds_read_b128 v[24:27], v5 offset:57344
  v_exp_f32 v80, v80
  v_exp_f32 v81, v81
  v_exp_f32 v82, v82
  v_exp_f32 v83, v83
  v_mfma_f32_32x32x16_bf16 v[104:119], v[44:47], v[100:103], v[104:119]
  ds_read_b128 v[28:31], v5 offset:58368
  v_exp_f32 v84, v84
  v_exp_f32 v85, v85
  v_exp_f32 v86, v86
  v_exp_f32 v87, v87
  v_mfma_f32_32x32x16_bf16 v[64:79], v[36:39], v[140:143], v[64:79]
  buffer_load_dwordx4 v4, s[4:7], s34 offen offset:2048 lds
  ds_read_b128 v[40:43], v5 offset:55296
  v_cvt_pk_bf16_f32 v96, v80, v81
  v_cvt_pk_bf16_f32 v97, v82, v83
  v_cvt_pk_bf16_f32 v98, v84, v85
  v_cvt_pk_bf16_f32 v99, v86, v87
  v_exp_f32 v88, v88
  v_exp_f32 v89, v89
  v_exp_f32 v90, v90
  v_exp_f32 v91, v91
  v_mfma_f32_32x32x16_bf16 v[104:119], v[48:51], v[96:99], v[104:119]
  ds_read_b128 v[44:47], v5 offset:56320
  v_exp_f32 v92, v92
  v_exp_f32 v93, v93
  v_exp_f32 v94, v94
  v_exp_f32 v95, v95
  s_waitcnt lgkmcnt(4)
  v_cvt_pk_bf16_f32 v100, v88, v89
  v_cvt_pk_bf16_f32 v101, v90, v91
  v_cvt_pk_bf16_f32 v102, v92, v93
  v_cvt_pk_bf16_f32 v103, v94, v95
  v_mfma_f32_32x32x16_bf16 v[80:95], v[16:19], v[136:139], v[120:135]
  ds_read_b128 v[32:35], v5 offset:61440
  v_exp_f32 v64, v64
  v_exp_f32 v65, v65
  v_exp_f32 v66, v66
  v_exp_f32 v67, v67
  v_mfma_f32_32x32x16_bf16 v[104:119], v[52:55], v[100:103], v[104:119]
  ds_read_b128 v[36:39], v5 offset:62464
  v_exp_f32 v68, v68
  v_exp_f32 v69, v69
  v_exp_f32 v70, v70
  v_exp_f32 v71, v71
  v_mfma_f32_32x32x16_bf16 v[80:95], v[20:23], v[140:143], v[80:95]
  buffer_load_dwordx4 v4, s[4:7], s34 offen offset:3072 lds
  ds_read_b128 v[48:51], v5 offset:59392
  v_cvt_pk_bf16_f32 v96, v64, v65
  v_cvt_pk_bf16_f32 v97, v66, v67
  v_cvt_pk_bf16_f32 v98, v68, v69
  v_cvt_pk_bf16_f32 v99, v70, v71
  v_exp_f32 v72, v72
  v_exp_f32 v73, v73
  v_exp_f32 v74, v74
  v_exp_f32 v75, v75
  v_mfma_f32_32x32x16_bf16 v[104:119], v[56:59], v[96:99], v[104:119]
  ds_read_b128 v[52:55], v5 offset:60416
  v_exp_f32 v76, v76
  v_exp_f32 v77, v77
  v_exp_f32 v78, v78
  v_exp_f32 v79, v79
  s_waitcnt lgkmcnt(4)
  v_cvt_pk_bf16_f32 v100, v72, v73
  v_cvt_pk_bf16_f32 v101, v74, v75
  v_cvt_pk_bf16_f32 v102, v76, v77
  v_cvt_pk_bf16_f32 v103, v78, v79
  v_mfma_f32_32x32x16_bf16 v[64:79], v[24:27], v[136:139], v[120:135]
  s_waitcnt vmcnt(40)
  s_barrier
  buffer_load_dwordx4 a[120:123], v4, s[4:7], s46 offen offset:3072
  ds_read_b128 v[16:19], v6 offset:0
  v_exp_f32 v80, v80
  v_exp_f32 v81, v81
  v_exp_f32 v82, v82
  v_exp_f32 v83, v83
  v_mfma_f32_32x32x16_bf16 v[104:119], v[60:63], v[100:103], v[104:119]
  ds_read_b128 v[20:23], v6 offset:1024
  v_exp_f32 v84, v84
  v_exp_f32 v85, v85
  v_exp_f32 v86, v86
  v_exp_f32 v87, v87
  v_mfma_f32_32x32x16_bf16 v[64:79], v[28:31], v[140:143], v[64:79]
  s_mov_b32 s33, s30
  s_add_u32 s30, s30, 16384
  s_add_u32 m0, s31, 32768
  s_nop 0
  buffer_load_dwordx4 v4, s[4:7], s33 offen offset:0 lds
  ds_read_b128 v[56:59], v5 offset:63488
  v_cvt_pk_bf16_f32 v96, v80, v81
  v_cvt_pk_bf16_f32 v97, v82, v83
  v_cvt_pk_bf16_f32 v98, v84, v85
  v_cvt_pk_bf16_f32 v99, v86, v87
  v_exp_f32 v88, v88
  v_exp_f32 v89, v89
  v_exp_f32 v90, v90
  v_exp_f32 v91, v91
  v_mfma_f32_32x32x16_bf16 v[104:119], v[40:43], v[96:99], v[104:119]
  ds_read_b128 v[60:63], v5 offset:64512
  v_exp_f32 v92, v92
  v_exp_f32 v93, v93
  v_exp_f32 v94, v94
  v_exp_f32 v95, v95
  s_waitcnt lgkmcnt(4)
  v_cvt_pk_bf16_f32 v100, v88, v89
  v_cvt_pk_bf16_f32 v101, v90, v91
  v_cvt_pk_bf16_f32 v102, v92, v93
  v_cvt_pk_bf16_f32 v103, v94, v95
  v_mfma_f32_32x32x16_bf16 v[80:95], v[32:35], v[136:139], v[120:135]
  buffer_load_dwordx4 a[124:127], v4, s[4:7], s47 offen offset:3072
  s_add_u32 s46, s46, 4096
  s_add_u32 s47, s47, 4096
  s_mul_i32 s50, s26, 112
  s_lshl_b32 s49, s27, 3
  s_add_u32 s50, s50, s49
  s_lshl_b32 s50, s50, 10
  s_add_u32 s50, s50, s23
  s_add_u32 s48, s50, 0
  buffer_load_dword v1, v13, s[4:7], s48 offen sc1
  ds_read_b128 v[24:27], v6 offset:4096
  v_exp_f32 v64, v64
  v_exp_f32 v65, v65
  v_exp_f32 v66, v66
  v_exp_f32 v67, v67
  v_mfma_f32_32x32x16_bf16 v[104:119], v[44:47], v[100:103], v[104:119]
  ds_read_b128 v[28:31], v6 offset:5120
  v_exp_f32 v68, v68
  v_exp_f32 v69, v69
  v_exp_f32 v70, v70
  v_exp_f32 v71, v71
  v_mfma_f32_32x32x16_bf16 v[80:95], v[36:39], v[140:143], v[80:95]
  buffer_load_dwordx4 v4, s[4:7], s33 offen offset:1024 lds
  ds_read_b128 v[40:43], v6 offset:2048
  v_cvt_pk_bf16_f32 v96, v64, v65
  v_cvt_pk_bf16_f32 v97, v66, v67
  v_cvt_pk_bf16_f32 v98, v68, v69
  v_cvt_pk_bf16_f32 v99, v70, v71
  v_exp_f32 v72, v72
  v_exp_f32 v73, v73
  v_exp_f32 v74, v74
  v_exp_f32 v75, v75
  v_mfma_f32_32x32x16_bf16 v[104:119], v[48:51], v[96:99], v[104:119]
  ds_read_b128 v[44:47], v6 offset:3072
  v_exp_f32 v76, v76
  v_exp_f32 v77, v77
  v_exp_f32 v78, v78
  v_exp_f32 v79, v79
  s_waitcnt lgkmcnt(4)
  v_cvt_pk_bf16_f32 v100, v72, v73
  v_cvt_pk_bf16_f32 v101, v74, v75
  v_cvt_pk_bf16_f32 v102, v76, v77
  v_cvt_pk_bf16_f32 v103, v78, v79
  v_mfma_f32_32x32x16_bf16 v[64:79], v[16:19], v[136:139], v[120:135]
  buffer_load_dwordx4 a[128:131], v4, s[4:7], s46 offen offset:0
  ds_read_b128 v[32:35], v6 offset:8192
  v_exp_f32 v80, v80
  v_exp_f32 v81, v81
  v_exp_f32 v82, v82
  v_exp_f32 v83, v83
  v_mfma_f32_32x32x16_bf16 v[104:119], v[52:55], v[100:103], v[104:119]
  ds_read_b128 v[36:39], v6 offset:9216
  v_exp_f32 v84, v84
  v_exp_f32 v85, v85
  v_exp_f32 v86, v86
  v_exp_f32 v87, v87
  v_mfma_f32_32x32x16_bf16 v[64:79], v[20:23], v[140:143], v[64:79]
  buffer_load_dwordx4 v4, s[4:7], s33 offen offset:2048 lds
  ds_read_b128 v[48:51], v6 offset:6144
  v_cvt_pk_bf16_f32 v96, v80, v81
  v_cvt_pk_bf16_f32 v97, v82, v83
  v_cvt_pk_bf16_f32 v98, v84, v85
  v_cvt_pk_bf16_f32 v99, v86, v87
  v_exp_f32 v88, v88
  v_exp_f32 v89, v89
  v_exp_f32 v90, v90
  v_exp_f32 v91, v91
  v_mfma_f32_32x32x16_bf16 v[104:119], v[56:59], v[96:99], v[104:119]
  ds_read_b128 v[52:55], v6 offset:7168
  v_exp_f32 v92, v92
  v_exp_f32 v93, v93
  v_exp_f32 v94, v94
  v_exp_f32 v95, v95
  s_waitcnt lgkmcnt(4)
  v_cvt_pk_bf16_f32 v100, v88, v89
  v_cvt_pk_bf16_f32 v101, v90, v91
  v_cvt_pk_bf16_f32 v102, v92, v93
  v_cvt_pk_bf16_f32 v103, v94, v95
  v_mfma_f32_32x32x16_bf16 v[80:95], v[24:27], v[136:139], v[120:135]
  buffer_load_dwordx4 a[132:135], v4, s[4:7], s47 offen offset:0
  ds_read_b128 v[16:19], v6 offset:12288
  v_exp_f32 v64, v64
  v_exp_f32 v65, v65
  v_exp_f32 v66, v66
  v_exp_f32 v67, v67
  v_mfma_f32_32x32x16_bf16 v[104:119], v[60:63], v[100:103], v[104:119]
  ds_read_b128 v[20:23], v6 offset:13312
  v_exp_f32 v68, v68
  v_exp_f32 v69, v69
  v_exp_f32 v70, v70
  v_exp_f32 v71, v71
  v_mfma_f32_32x32x16_bf16 v[80:95], v[28:31], v[140:143], v[80:95]
  buffer_load_dwordx4 v4, s[4:7], s33 offen offset:3072 lds
  ds_read_b128 v[56:59], v6 offset:10240
  v_cvt_pk_bf16_f32 v96, v64, v65
  v_cvt_pk_bf16_f32 v97, v66, v67
  v_cvt_pk_bf16_f32 v98, v68, v69
  v_cvt_pk_bf16_f32 v99, v70, v71
  v_exp_f32 v72, v72
  v_exp_f32 v73, v73
  v_exp_f32 v74, v74
  v_exp_f32 v75, v75
  v_mfma_f32_32x32x16_bf16 v[104:119], v[40:43], v[96:99], v[104:119]
  ds_read_b128 v[60:63], v6 offset:11264
  v_exp_f32 v76, v76
  v_exp_f32 v77, v77
  v_exp_f32 v78, v78
  v_exp_f32 v79, v79
  s_waitcnt lgkmcnt(4)
  v_cvt_pk_bf16_f32 v100, v72, v73
  v_cvt_pk_bf16_f32 v101, v74, v75
  v_cvt_pk_bf16_f32 v102, v76, v77
  v_cvt_pk_bf16_f32 v103, v78, v79
  v_mfma_f32_32x32x16_bf16 v[64:79], v[32:35], v[136:139], v[120:135]
  s_waitcnt vmcnt(42)
  s_barrier
  ds_read_b128 v[24:27], v6 offset:16384
  v_exp_f32 v80, v80
  v_exp_f32 v81, v81
  v_exp_f32 v82, v82
  v_exp_f32 v83, v83
  v_mfma_f32_32x32x16_bf16 v[104:119], v[44:47], v[100:103], v[104:119]
  ds_read_b128 v[28:31], v6 offset:17408
  v_exp_f32 v84, v84
  v_exp_f32 v85, v85
  v_exp_f32 v86, v86
  v_exp_f32 v87, v87
  v_mfma_f32_32x32x16_bf16 v[64:79], v[36:39], v[140:143], v[64:79]
  s_mov_b32 s34, s30
  s_add_u32 s30, s30, 16384
  s_add_u32 m0, s31, 49152
  s_nop 0
  buffer_load_dwordx4 v4, s[4:7], s34 offen offset:0 lds
  ds_read_b128 v[40:43], v6 offset:14336
  v_cvt_pk_bf16_f32 v96, v80, v81
  v_cvt_pk_bf16_f32 v97, v82, v83
  v_cvt_pk_bf16_f32 v98, v84, v85
  v_cvt_pk_bf16_f32 v99, v86, v87
  v_exp_f32 v88, v88
  v_exp_f32 v89, v89
  v_exp_f32 v90, v90
  v_exp_f32 v91, v91
  v_mfma_f32_32x32x16_bf16 v[104:119], v[48:51], v[96:99], v[104:119]
  ds_read_b128 v[44:47], v6 offset:15360
  v_exp_f32 v92, v92
  v_exp_f32 v93, v93
  v_exp_f32 v94, v94
  v_exp_f32 v95, v95
  s_waitcnt lgkmcnt(4)
  v_cvt_pk_bf16_f32 v100, v88, v89
  v_cvt_pk_bf16_f32 v101, v90, v91
  v_cvt_pk_bf16_f32 v102, v92, v93
  v_cvt_pk_bf16_f32 v103, v94, v95
  v_mfma_f32_32x32x16_bf16 v[80:95], v[16:19], v[136:139], v[120:135]
  buffer_load_dwordx4 a[136:139], v4, s[4:7], s46 offen offset:1024
  s_add_u32 s48, s50, 2048
  buffer_load_dword v1, v13, s[4:7], s48 offen sc1
  ds_read_b128 v[32:35], v6 offset:20480
  v_exp_f32 v64, v64
  v_exp_f32 v65, v65
  v_exp_f32 v66, v66
  v_exp_f32 v67, v67
  v_mfma_f32_32x32x16_bf16 v[104:119], v[52:55], v[100:103], v[104:119]
  ds_read_b128 v[36:39], v6 offset:21504
  v_exp_f32 v68, v68
  v_exp_f32 v69, v69
  v_exp_f32 v70, v70
  v_exp_f32 v71, v71
  v_mfma_f32_32x32x16_bf16 v[80:95], v[20:23], v[140:143], v[80:95]
  buffer_load_dwordx4 v4, s[4:7], s34 offen offset:1024 lds
  ds_read_b128 v[48:51], v6 offset:18432
  v_cvt_pk_bf16_f32 v96, v64, v65
  v_cvt_pk_bf16_f32 v97, v66, v67
  v_cvt_pk_bf16_f32 v98, v68, v69
  v_cvt_pk_bf16_f32 v99, v70, v71
  v_exp_f32 v72, v72
  v_exp_f32 v73, v73
  v_exp_f32 v74, v74
  v_exp_f32 v75, v75
  v_mfma_f32_32x32x16_bf16 v[104:119], v[56:59], v[96:99], v[104:119]
  ds_read_b128 v[52:55], v6 offset:19456
  v_exp_f32 v76, v76
  v_exp_f32 v77, v77
  v_exp_f32 v78, v78
  v_exp_f32 v79, v79
  s_waitcnt lgkmcnt(4)
  v_cvt_pk_bf16_f32 v100, v72, v73
  v_cvt_pk_bf16_f32 v101, v74, v75
  v_cvt_pk_bf16_f32 v102, v76, v77
  v_cvt_pk_bf16_f32 v103, v78, v79
  v_mfma_f32_32x32x16_bf16 v[64:79], v[24:27], v[136:139], v[120:135]
  buffer_load_dwordx4 a[140:143], v4, s[4:7], s47 offen offset:1024
  ds_read_b128 v[16:19], v6 offset:24576
  v_exp_f32 v80, v80
  v_exp_f32 v81, v81
  v_exp_f32 v82, v82
  v_exp_f32 v83, v83
  v_mfma_f32_32x32x16_bf16 v[104:119], v[60:63], v[100:103], v[104:119]
  ds_read_b128 v[20:23], v6 offset:25600
  v_exp_f32 v84, v84
  v_exp_f32 v85, v85
  v_exp_f32 v86, v86
  v_exp_f32 v87, v87
  v_mfma_f32_32x32x16_bf16 v[64:79], v[28:31], v[140:143], v[64:79]
  buffer_load_dwordx4 v4, s[4:7], s34 offen offset:2048 lds
  ds_read_b128 v[56:59], v6 offset:22528
  v_cvt_pk_bf16_f32 v96, v80, v81
  v_cvt_pk_bf16_f32 v97, v82, v83
  v_cvt_pk_bf16_f32 v98, v84, v85
  v_cvt_pk_bf16_f32 v99, v86, v87
  v_exp_f32 v88, v88
  v_exp_f32 v89, v89
  v_exp_f32 v90, v90
  v_exp_f32 v91, v91
  v_mfma_f32_32x32x16_bf16 v[104:119], v[40:43], v[96:99], v[104:119]
  ds_read_b128 v[60:63], v6 offset:23552
  v_exp_f32 v92, v92
  v_exp_f32 v93, v93
  v_exp_f32 v94, v94
  v_exp_f32 v95, v95
  s_waitcnt lgkmcnt(4)
  v_cvt_pk_bf16_f32 v100, v88, v89
  v_cvt_pk_bf16_f32 v101, v90, v91
  v_cvt_pk_bf16_f32 v102, v92, v93
  v_cvt_pk_bf16_f32 v103, v94, v95
  v_mfma_f32_32x32x16_bf16 v[80:95], v[32:35], v[136:139], v[120:135]
  buffer_load_dwordx4 a[144:147], v4, s[4:7], s46 offen offset:2048
  ds_read_b128 v[24:27], v6 offset:28672
  v_exp_f32 v64, v64
  v_exp_f32 v65, v65
  v_exp_f32 v66, v66
  v_exp_f32 v67, v67
  v_mfma_f32_32x32x16_bf16 v[104:119], v[44:47], v[100:103], v[104:119]
  ds_read_b128 v[28:31], v6 offset:29696
  v_exp_f32 v68, v68
  v_exp_f32 v69, v69
  v_exp_f32 v70, v70
  v_exp_f32 v71, v71
  v_mfma_f32_32x32x16_bf16 v[80:95], v[36:39], v[140:143], v[80:95]
  buffer_load_dwordx4 v4, s[4:7], s34 offen offset:3072 lds
  ds_read_b128 v[40:43], v6 offset:26624
  v_cvt_pk_bf16_f32 v96, v64, v65
  v_cvt_pk_bf16_f32 v97, v66, v67
  v_cvt_pk_bf16_f32 v98, v68, v69
  v_cvt_pk_bf16_f32 v99, v70, v71
  v_exp_f32 v72, v72
  v_exp_f32 v73, v73
  v_exp_f32 v74, v74
  v_exp_f32 v75, v75
  v_mfma_f32_32x32x16_bf16 v[104:119], v[48:51], v[96:99], v[104:119]
  ds_read_b128 v[44:47], v6 offset:27648
  v_exp_f32 v76, v76
  v_exp_f32 v77, v77
  v_exp_f32 v78, v78
  v_exp_f32 v79, v79
  s_waitcnt lgkmcnt(4)
  v_cvt_pk_bf16_f32 v100, v72, v73
  v_cvt_pk_bf16_f32 v101, v74, v75
  v_cvt_pk_bf16_f32 v102, v76, v77
  v_cvt_pk_bf16_f32 v103, v78, v79
  v_mfma_f32_32x32x16_bf16 v[64:79], v[16:19], v[136:139], v[120:135]
  s_waitcnt vmcnt(42)
  s_barrier
  ds_read_b128 v[32:35], v6 offset:32768
  v_exp_f32 v80, v80
  v_exp_f32 v81, v81
  v_exp_f32 v82, v82
  v_exp_f32 v83, v83
  v_mfma_f32_32x32x16_bf16 v[104:119], v[52:55], v[100:103], v[104:119]
  ds_read_b128 v[36:39], v6 offset:33792
  v_exp_f32 v84, v84
  v_exp_f32 v85, v85
  v_exp_f32 v86, v86
  v_exp_f32 v87, v87
  v_mfma_f32_32x32x16_bf16 v[64:79], v[20:23], v[140:143], v[64:79]
  s_mov_b32 s33, s30
  s_add_u32 s30, s30, 16384
  s_add_u32 m0, s31, 65536
  s_nop 0
  buffer_load_dwordx4 v4, s[4:7], s33 offen offset:0 lds
  ds_read_b128 v[48:51], v6 offset:30720
  v_cvt_pk_bf16_f32 v96, v80, v81
  v_cvt_pk_bf16_f32 v97, v82, v83
  v_cvt_pk_bf16_f32 v98, v84, v85
  v_cvt_pk_bf16_f32 v99, v86, v87
  v_exp_f32 v88, v88
  v_exp_f32 v89, v89
  v_exp_f32 v90, v90
  v_exp_f32 v91, v91
  v_mfma_f32_32x32x16_bf16 v[104:119], v[56:59], v[96:99], v[104:119]
  ds_read_b128 v[52:55], v6 offset:31744
  v_exp_f32 v92, v92
  v_exp_f32 v93, v93
  v_exp_f32 v94, v94
  v_exp_f32 v95, v95
  s_waitcnt lgkmcnt(4)
  v_cvt_pk_bf16_f32 v100, v88, v89
  v_cvt_pk_bf16_f32 v101, v90, v91
  v_cvt_pk_bf16_f32 v102, v92, v93
  v_cvt_pk_bf16_f32 v103, v94, v95
  v_mfma_f32_32x32x16_bf16 v[80:95], v[24:27], v[136:139], v[120:135]
  buffer_load_dwordx4 a[148:151], v4, s[4:7], s47 offen offset:2048
  s_add_u32 s48, s50, 4096
  buffer_load_dword v1, v13, s[4:7], s48 offen sc1
  ds_read_b128 v[16:19], v6 offset:36864
  v_exp_f32 v64, v64
  v_exp_f32 v65, v65
  v_exp_f32 v66, v66
  v_exp_f32 v67, v67
  v_mfma_f32_32x32x16_bf16 v[104:119], v[60:63], v[100:103], v[104:119]
  ds_read_b128 v[20:23], v6 offset:37888
  v_exp_f32 v68, v68
  v_exp_f32 v69, v69
  v_exp_f32 v70, v70
  v_exp_f32 v71, v71
  v_mfma_f32_32x32x16_bf16 v[80:95], v[28:31], v[140:143], v[80:95]
  buffer_load_dwordx4 v4, s[4:7], s33 offen offset:1024 lds
  ds_read_b128 v[56:59], v6 offset:34816
  v_cvt_pk_bf16_f32 v96, v64, v65
  v_cvt_pk_bf16_f32 v97, v66, v67
  v_cvt_pk_bf16_f32 v98, v68, v69
  v_cvt_pk_bf16_f32 v99, v70, v71
  v_exp_f32 v72, v72
  v_exp_f32 v73, v73
  v_exp_f32 v74, v74
  v_exp_f32 v75, v75
  v_mfma_f32_32x32x16_bf16 v[104:119], v[40:43], v[96:99], v[104:119]
  ds_read_b128 v[60:63], v6 offset:35840
  v_exp_f32 v76, v76
  v_exp_f32 v77, v77
  v_exp_f32 v78, v78
  v_exp_f32 v79, v79
  s_waitcnt lgkmcnt(4)
  v_cvt_pk_bf16_f32 v100, v72, v73
  v_cvt_pk_bf16_f32 v101, v74, v75
  v_cvt_pk_bf16_f32 v102, v76, v77
  v_cvt_pk_bf16_f32 v103, v78, v79
  v_mfma_f32_32x32x16_bf16 v[64:79], v[32:35], v[136:139], v[120:135]
  buffer_load_dwordx4 a[152:155], v4, s[4:7], s46 offen offset:3072
  ds_read_b128 v[24:27], v6 offset:40960
  v_exp_f32 v80, v80
  v_exp_f32 v81, v81
  v_exp_f32 v82, v82
  v_exp_f32 v83, v83
  v_mfma_f32_32x32x16_bf16 v[104:119], v[44:47], v[100:103], v[104:119]
  ds_read_b128 v[28:31], v6 offset:41984
  v_exp_f32 v84, v84
  v_exp_f32 v85, v85
  v_exp_f32 v86, v86
  v_exp_f32 v87, v87
  v_mfma_f32_32x32x16_bf16 v[64:79], v[36:39], v[140:143], v[64:79]
  buffer_load_dwordx4 v4, s[4:7], s33 offen offset:2048 lds
  ds_read_b128 v[40:43], v6 offset:38912
  v_cvt_pk_bf16_f32 v96, v80, v81
  v_cvt_pk_bf16_f32 v97, v82, v83
  v_cvt_pk_bf16_f32 v98, v84, v85
  v_cvt_pk_bf16_f32 v99, v86, v87
  v_exp_f32 v88, v88
  v_exp_f32 v89, v89
  v_exp_f32 v90, v90
  v_exp_f32 v91, v91
  v_mfma_f32_32x32x16_bf16 v[104:119], v[48:51], v[96:99], v[104:119]
  ds_read_b128 v[44:47], v6 offset:39936
  v_exp_f32 v92, v92
  v_exp_f32 v93, v93
  v_exp_f32 v94, v94
  v_exp_f32 v95, v95
  s_waitcnt lgkmcnt(4)
  v_cvt_pk_bf16_f32 v100, v88, v89
  v_cvt_pk_bf16_f32 v101, v90, v91
  v_cvt_pk_bf16_f32 v102, v92, v93
  v_cvt_pk_bf16_f32 v103, v94, v95
  v_mfma_f32_32x32x16_bf16 v[80:95], v[16:19], v[136:139], v[120:135]
  buffer_load_dwordx4 a[156:159], v4, s[4:7], s47 offen offset:3072
  s_add_u32 s46, s46, 4096
  s_add_u32 s47, s47, 4096
  ds_read_b128 v[32:35], v6 offset:45056
  v_exp_f32 v64, v64
  v_exp_f32 v65, v65
  v_exp_f32 v66, v66
  v_exp_f32 v67, v67
  v_mfma_f32_32x32x16_bf16 v[104:119], v[52:55], v[100:103], v[104:119]
  ds_read_b128 v[36:39], v6 offset:46080
  v_exp_f32 v68, v68
  v_exp_f32 v69, v69
  v_exp_f32 v70, v70
  v_exp_f32 v71, v71
  v_mfma_f32_32x32x16_bf16 v[80:95], v[20:23], v[140:143], v[80:95]
  buffer_load_dwordx4 v4, s[4:7], s33 offen offset:3072 lds
  ds_read_b128 v[48:51], v6 offset:43008
  v_cvt_pk_bf16_f32 v96, v64, v65
  v_cvt_pk_bf16_f32 v97, v66, v67
  v_cvt_pk_bf16_f32 v98, v68, v69
  v_cvt_pk_bf16_f32 v99, v70, v71
  v_exp_f32 v72, v72
  v_exp_f32 v73, v73
  v_exp_f32 v74, v74
  v_exp_f32 v75, v75
  v_mfma_f32_32x32x16_bf16 v[104:119], v[56:59], v[96:99], v[104:119]
  ds_read_b128 v[52:55], v6 offset:44032
  v_exp_f32 v76, v76
  v_exp_f32 v77, v77
  v_exp_f32 v78, v78
  v_exp_f32 v79, v79
  s_waitcnt lgkmcnt(4)
  v_cvt_pk_bf16_f32 v100, v72, v73
  v_cvt_pk_bf16_f32 v101, v74, v75
  v_cvt_pk_bf16_f32 v102, v76, v77
  v_cvt_pk_bf16_f32 v103, v78, v79
  v_mfma_f32_32x32x16_bf16 v[64:79], v[24:27], v[136:139], v[120:135]
  s_waitcnt vmcnt(42)
  s_barrier
  ds_read_b128 v[16:19], v6 offset:49152
  v_exp_f32 v80, v80
  v_exp_f32 v81, v81
  v_exp_f32 v82, v82
  v_exp_f32 v83, v83
  v_mfma_f32_32x32x16_bf16 v[104:119], v[60:63], v[100:103], v[104:119]
  ds_read_b128 v[20:23], v6 offset:50176
  v_exp_f32 v84, v84
  v_exp_f32 v85, v85
  v_exp_f32 v86, v86
  v_exp_f32 v87, v87
  v_mfma_f32_32x32x16_bf16 v[64:79], v[28:31], v[140:143], v[64:79]
  s_mov_b32 s34, s30
  s_add_u32 s30, s30, 16384
  s_add_u32 m0, s31, 81920
  s_nop 0
  buffer_load_dwordx4 v4, s[4:7], s34 offen offset:0 lds
  ds_read_b128 v[56:59], v6 offset:47104
  v_cvt_pk_bf16_f32 v96, v80, v81
  v_cvt_pk_bf16_f32 v97, v82, v83
  v_cvt_pk_bf16_f32 v98, v84, v85
  v_cvt_pk_bf16_f32 v99, v86, v87
  v_exp_f32 v88, v88
  v_exp_f32 v89, v89
  v_exp_f32 v90, v90
  v_exp_f32 v91, v91
  v_mfma_f32_32x32x16_bf16 v[104:119], v[40:43], v[96:99], v[104:119]
  ds_read_b128 v[60:63], v6 offset:48128
  v_exp_f32 v92, v92
  v_exp_f32 v93, v93
  v_exp_f32 v94, v94
  v_exp_f32 v95, v95
  s_waitcnt lgkmcnt(4)
  v_cvt_pk_bf16_f32 v100, v88, v89
  v_cvt_pk_bf16_f32 v101, v90, v91
  v_cvt_pk_bf16_f32 v102, v92, v93
  v_cvt_pk_bf16_f32 v103, v94, v95
  v_mfma_f32_32x32x16_bf16 v[80:95], v[32:35], v[136:139], v[120:135]
  s_add_u32 s48, s50, 6144
  buffer_load_dword v1, v13, s[4:7], s48 offen sc1
  ds_read_b128 v[24:27], v6 offset:53248
  v_exp_f32 v64, v64
  v_exp_f32 v65, v65
  v_exp_f32 v66, v66
  v_exp_f32 v67, v67
  v_mfma_f32_32x32x16_bf16 v[104:119], v[44:47], v[100:103], v[104:119]
  ds_read_b128 v[28:31], v6 offset:54272
  v_exp_f32 v68, v68
  v_exp_f32 v69, v69
  v_exp_f32 v70, v70
  v_exp_f32 v71, v71
  v_mfma_f32_32x32x16_bf16 v[80:95], v[36:39], v[140:143], v[80:95]
  buffer_load_dwordx4 v4, s[4:7], s34 offen offset:1024 lds
  ds_read_b128 v[40:43], v6 offset:51200
  v_cvt_pk_bf16_f32 v96, v64, v65
  v_cvt_pk_bf16_f32 v97, v66, v67
  v_cvt_pk_bf16_f32 v98, v68, v69
  v_cvt_pk_bf16_f32 v99, v70, v71
  v_exp_f32 v72, v72
  v_exp_f32 v73, v73
  v_exp_f32 v74, v74
  v_exp_f32 v75, v75
  v_mfma_f32_32x32x16_bf16 v[104:119], v[48:51], v[96:99], v[104:119]
  ds_read_b128 v[44:47], v6 offset:52224
  v_exp_f32 v76, v76
  v_exp_f32 v77, v77
  v_exp_f32 v78, v78
  v_exp_f32 v79, v79
  s_waitcnt lgkmcnt(4)
  v_cvt_pk_bf16_f32 v100, v72, v73
  v_cvt_pk_bf16_f32 v101, v74, v75
  v_cvt_pk_bf16_f32 v102, v76, v77
  v_cvt_pk_bf16_f32 v103, v78, v79
  v_mfma_f32_32x32x16_bf16 v[64:79], v[16:19], v[136:139], v[120:135]
  ds_read_b128 v[32:35], v6 offset:57344
  v_exp_f32 v80, v80
  v_exp_f32 v81, v81
  v_exp_f32 v82, v82
  v_exp_f32 v83, v83
  v_mfma_f32_32x32x16_bf16 v[104:119], v[52:55], v[100:103], v[104:119]
  ds_read_b128 v[36:39], v6 offset:58368
  v_exp_f32 v84, v84
  v_exp_f32 v85, v85
  v_exp_f32 v86, v86
  v_exp_f32 v87, v87
  v_mfma_f32_32x32x16_bf16 v[64:79], v[20:23], v[140:143], v[64:79]
  buffer_load_dwordx4 v4, s[4:7], s34 offen offset:2048 lds
  ds_read_b128 v[48:51], v6 offset:55296
  v_cvt_pk_bf16_f32 v96, v80, v81
  v_cvt_pk_bf16_f32 v97, v82, v83
  v_cvt_pk_bf16_f32 v98, v84, v85
  v_cvt_pk_bf16_f32 v99, v86, v87
  v_exp_f32 v88, v88
  v_exp_f32 v89, v89
  v_exp_f32 v90, v90
  v_exp_f32 v91, v91
  v_mfma_f32_32x32x16_bf16 v[104:119], v[56:59], v[96:99], v[104:119]
  ds_read_b128 v[52:55], v6 offset:56320
  v_exp_f32 v92, v92
  v_exp_f32 v93, v93
  v_exp_f32 v94, v94
  v_exp_f32 v95, v95
  s_waitcnt lgkmcnt(4)
  v_cvt_pk_bf16_f32 v100, v88, v89
  v_cvt_pk_bf16_f32 v101, v90, v91
  v_cvt_pk_bf16_f32 v102, v92, v93
  v_cvt_pk_bf16_f32 v103, v94, v95
  v_mfma_f32_32x32x16_bf16 v[80:95], v[24:27], v[136:139], v[120:135]
  ds_read_b128 v[16:19], v6 offset:61440
  v_exp_f32 v64, v64
  v_exp_f32 v65, v65
  v_exp_f32 v66, v66
  v_exp_f32 v67, v67
  v_mfma_f32_32x32x16_bf16 v[104:119], v[60:63], v[100:103], v[104:119]
  ds_read_b128 v[20:23], v6 offset:62464
  v_exp_f32 v68, v68
  v_exp_f32 v69, v69
  v_exp_f32 v70, v70
  v_exp_f32 v71, v71
  v_mfma_f32_32x32x16_bf16 v[80:95], v[28:31], v[140:143], v[80:95]
  buffer_load_dwordx4 v4, s[4:7], s34 offen offset:3072 lds
  ds_read_b128 v[56:59], v6 offset:59392
  v_cvt_pk_bf16_f32 v96, v64, v65
  v_cvt_pk_bf16_f32 v97, v66, v67
  v_cvt_pk_bf16_f32 v98, v68, v69
  v_cvt_pk_bf16_f32 v99, v70, v71
  v_exp_f32 v72, v72
  v_exp_f32 v73, v73
  v_exp_f32 v74, v74
  v_exp_f32 v75, v75
  v_mfma_f32_32x32x16_bf16 v[104:119], v[40:43], v[96:99], v[104:119]
  ds_read_b128 v[60:63], v6 offset:60416
  v_exp_f32 v76, v76
  v_exp_f32 v77, v77
  v_exp_f32 v78, v78
  v_exp_f32 v79, v79
  s_waitcnt lgkmcnt(0)
  v_cvt_pk_bf16_f32 v100, v72, v73
  v_cvt_pk_bf16_f32 v101, v74, v75
  v_cvt_pk_bf16_f32 v102, v76, v77
  v_cvt_pk_bf16_f32 v103, v78, v79
  v_mfma_f32_32x32x16_bf16 v[64:79], v[32:35], v[136:139], v[120:135]
  s_barrier
  s_nop 0
  v_exp_f32 v80, v80
  v_exp_f32 v81, v81
  v_exp_f32 v82, v82
  v_exp_f32 v83, v83
  v_mfma_f32_32x32x16_bf16 v[104:119], v[44:47], v[100:103], v[104:119]
  s_nop 0
  v_exp_f32 v84, v84
  v_exp_f32 v85, v85
  v_exp_f32 v86, v86
  v_exp_f32 v87, v87
  v_mfma_f32_32x32x16_bf16 v[64:79], v[36:39], v[140:143], v[64:79]
  s_mov_b32 s33, s30
  s_add_u32 s30, s30, 16384
  s_add_u32 m0, s31, 98304
  s_nop 0
  buffer_load_dwordx4 v4, s[4:7], s33 offen offset:0 lds
  ds_read_b128 v[40:43], v6 offset:63488
  v_cvt_pk_bf16_f32 v96, v80, v81
  v_cvt_pk_bf16_f32 v97, v82, v83
  v_cvt_pk_bf16_f32 v98, v84, v85
  v_cvt_pk_bf16_f32 v99, v86, v87
  v_exp_f32 v88, v88
  v_exp_f32 v89, v89
  v_exp_f32 v90, v90
  v_exp_f32 v91, v91
  v_mfma_f32_32x32x16_bf16 v[104:119], v[48:51], v[96:99], v[104:119]
  ds_read_b128 v[44:47], v6 offset:64512
  v_exp_f32 v92, v92
  v_exp_f32 v93, v93
  v_exp_f32 v94, v94
  v_exp_f32 v95, v95
  s_waitcnt lgkmcnt(0)
  v_cvt_pk_bf16_f32 v100, v88, v89
  v_cvt_pk_bf16_f32 v101, v90, v91
  v_cvt_pk_bf16_f32 v102, v92, v93
  v_cvt_pk_bf16_f32 v103, v94, v95
  v_mfma_f32_32x32x16_bf16 v[80:95], v[16:19], v[136:139], v[120:135]
  s_nop 0
  v_exp_f32 v64, v64
  v_exp_f32 v65, v65
  v_exp_f32 v66, v66
  v_exp_f32 v67, v67
  v_mfma_f32_32x32x16_bf16 v[104:119], v[52:55], v[100:103], v[104:119]
  s_nop 0
  v_exp_f32 v68, v68
  v_exp_f32 v69, v69
  v_exp_f32 v70, v70
  v_exp_f32 v71, v71
  v_mfma_f32_32x32x16_bf16 v[80:95], v[20:23], v[140:143], v[80:95]
  buffer_load_dwordx4 v4, s[4:7], s33 offen offset:1024 lds
  s_nop 0
  v_cvt_pk_bf16_f32 v96, v64, v65
  v_cvt_pk_bf16_f32 v97, v66, v67
  v_cvt_pk_bf16_f32 v98, v68, v69
  v_cvt_pk_bf16_f32 v99, v70, v71
  v_exp_f32 v72, v72
  v_exp_f32 v73, v73
  v_exp_f32 v74, v74
  v_exp_f32 v75, v75
  v_mfma_f32_32x32x16_bf16 v[104:119], v[56:59], v[96:99], v[104:119]
  s_nop 0
  v_exp_f32 v76, v76
  v_exp_f32 v77, v77
  v_exp_f32 v78, v78
  v_exp_f32 v79, v79
  s_waitcnt lgkmcnt(0)
  v_cvt_pk_bf16_f32 v100, v72, v73
  v_cvt_pk_bf16_f32 v101, v74, v75
  v_cvt_pk_bf16_f32 v102, v76, v77
  v_cvt_pk_bf16_f32 v103, v78, v79
  s_nop 0
  v_exp_f32 v80, v80
  v_exp_f32 v81, v81
  v_exp_f32 v82, v82
  v_exp_f32 v83, v83
  v_mfma_f32_32x32x16_bf16 v[104:119], v[60:63], v[100:103], v[104:119]
  s_nop 0
  v_exp_f32 v84, v84
  v_exp_f32 v85, v85
  v_exp_f32 v86, v86
  v_exp_f32 v87, v87
  buffer_load_dwordx4 v4, s[4:7], s33 offen offset:2048 lds
  s_nop 0
  v_cvt_pk_bf16_f32 v96, v80, v81
  v_cvt_pk_bf16_f32 v97, v82, v83
  v_cvt_pk_bf16_f32 v98, v84, v85
  v_cvt_pk_bf16_f32 v99, v86, v87
  v_exp_f32 v88, v88
  v_exp_f32 v89, v89
  v_exp_f32 v90, v90
  v_exp_f32 v91, v91
  v_mfma_f32_32x32x16_bf16 v[104:119], v[40:43], v[96:99], v[104:119]
  s_nop 0
  v_exp_f32 v92, v92
  v_exp_f32 v93, v93
  v_exp_f32 v94, v94
  v_exp_f32 v95, v95
  s_waitcnt lgkmcnt(0)
  v_cvt_pk_bf16_f32 v100, v88, v89
  v_cvt_pk_bf16_f32 v101, v90, v91
  v_cvt_pk_bf16_f32 v102, v92, v93
  v_cvt_pk_bf16_f32 v103, v94, v95
  buffer_load_dwordx4 v4, s[4:7], s33 offen offset:3072 lds
  s_nop 1
  v_mfma_f32_32x32x16_bf16 v[104:119], v[44:47], v[100:103], v[104:119]
  s_nop 7
  s_nop 7
  v_pk_mul_f32 v[10:11], v[104:105], 0 op_sel_hi:[1,0]
  v_pk_fma_f32 v[10:11], v[106:107], 0, v[10:11] op_sel_hi:[1,0,1]
  v_pk_fma_f32 v[10:11], v[108:109], 0, v[10:11] op_sel_hi:[1,0,1]
  v_pk_fma_f32 v[10:11], v[110:111], 0, v[10:11] op_sel_hi:[1,0,1]
  v_pk_fma_f32 v[10:11], v[112:113], 0, v[10:11] op_sel_hi:[1,0,1]
  v_pk_fma_f32 v[10:11], v[114:115], 0, v[10:11] op_sel_hi:[1,0,1]
  v_pk_fma_f32 v[10:11], v[116:117], 0, v[10:11] op_sel_hi:[1,0,1]
  v_pk_fma_f32 v[10:11], v[118:119], 0, v[10:11] op_sel_hi:[1,0,1]
  v_add_f32 v10, v10, v11
  v_cmp_u_f32 vcc, v10, v10
  s_cbranch_vccz attn_ok
  v_mov_b32 v104, 0
  v_mov_b32 v105, 0
  v_mov_b32 v106, 0
  v_mov_b32 v107, 0
  v_mov_b32 v108, 0
  v_mov_b32 v109, 0
  v_mov_b32 v110, 0
  v_mov_b32 v111, 0
  v_mov_b32 v112, 0
  v_mov_b32 v113, 0
  v_mov_b32 v114, 0
  v_mov_b32 v115, 0
  v_mov_b32 v116, 0
  v_mov_b32 v117, 0
  v_mov_b32 v118, 0
  v_mov_b32 v119, 0
  v_mov_b32 v7, 0xff800000
  s_lshl_b32 s30, s27, 18
  s_add_u32 s30, s30, s19
  s_mov_b32 s33, 0
fb_loop:
  buffer_load_dwordx4 v[16:19], v4, s[4:7], s30 offen
  buffer_load_dwordx4 v[20:23], v4, s[4:7], s30 offen offset:1024
  buffer_load_dwordx4 v[40:43], v4, s[4:7], s30 offen offset:2048
  buffer_load_dwordx4 v[44:47], v4, s[4:7], s30 offen offset:3072
  s_waitcnt vmcnt(0)
  v_mfma_f32_32x32x16_bf16 v[64:79], v[16:19], v[136:139], 0
  v_mfma_f32_32x32x16_bf16 v[64:79], v[20:23], v[140:143], v[64:79]
  s_nop 7
  s_nop 7
  v_max3_f32 v8, v64, v65, v66
  v_max3_f32 v8, v8, v67, v68
  v_max3_f32 v8, v8, v69, v70
  v_max3_f32 v8, v8, v71, v72
  v_max3_f32 v8, v8, v73, v74
  v_max3_f32 v8, v8, v75, v76
  v_max3_f32 v8, v8, v77, v78
  v_max_f32 v8, v8, v79
  v_mov_b32 v9, v8
  s_nop 1
  v_permlane32_swap_b32 v8, v9
  s_nop 1
  v_max_f32 v8, v8, v9
  v_max_f32 v9, v7, v8
  v_sub_f32 v10, v7, v9
  v_exp_f32 v10, v10
  v_mov_b32 v7, v9
  v_sub_f32 v64, v64, v9
  v_sub_f32 v65, v65, v9
  v_sub_f32 v66, v66, v9
  v_sub_f32 v67, v67, v9
  v_sub_f32 v68, v68, v9
  v_sub_f32 v69, v69, v9
  v_sub_f32 v70, v70, v9
  v_sub_f32 v71, v71, v9
  v_sub_f32 v72, v72, v9
  v_sub_f32 v73, v73, v9
  v_sub_f32 v74, v74, v9
  v_sub_f32 v75, v75, v9
  v_sub_f32 v76, v76, v9
  v_sub_f32 v77, v77, v9
  v_sub_f32 v78, v78, v9
  v_sub_f32 v79, v79, v9
  v_exp_f32 v64, v64
  v_exp_f32 v65, v65
  v_exp_f32 v66, v66
  v_exp_f32 v67, v67
  v_exp_f32 v68, v68
  v_exp_f32 v69, v69
  v_exp_f32 v70, v70
  v_exp_f32 v71, v71
  v_exp_f32 v72, v72
  v_exp_f32 v73, v73
  v_exp_f32 v74, v74
  v_exp_f32 v75, v75
  v_exp_f32 v76, v76
  v_exp_f32 v77, v77
  v_exp_f32 v78, v78
  v_exp_f32 v79, v79
  v_pk_mul_f32 v[104:105], v[104:105], v[10:11] op_sel_hi:[1,0]
  v_pk_mul_f32 v[106:107], v[106:107], v[10:11] op_sel_hi:[1,0]
  v_pk_mul_f32 v[108:109], v[108:109], v[10:11] op_sel_hi:[1,0]
  v_pk_mul_f32 v[110:111], v[110:111], v[10:11] op_sel_hi:[1,0]
  v_pk_mul_f32 v[112:113], v[112:113], v[10:11] op_sel_hi:[1,0]
  v_pk_mul_f32 v[114:115], v[114:115], v[10:11] op_sel_hi:[1,0]
  v_pk_mul_f32 v[116:117], v[116:117], v[10:11] op_sel_hi:[1,0]
  v_pk_mul_f32 v[118:119], v[118:119], v[10:11] op_sel_hi:[1,0]
  v_cvt_pk_bf16_f32 v96, v64, v65
  v_cvt_pk_bf16_f32 v97, v66, v67
  v_cvt_pk_bf16_f32 v98, v68, v69
  v_cvt_pk_bf16_f32 v99, v70, v71
  v_cvt_pk_bf16_f32 v100, v72, v73
  v_cvt_pk_bf16_f32 v101, v74, v75
  v_cvt_pk_bf16_f32 v102, v76, v77
  v_cvt_pk_bf16_f32 v103, v78, v79
  s_nop 1
  v_mfma_f32_32x32x16_bf16 v[104:119], v[40:43], v[96:99], v[104:119]
  v_mfma_f32_32x32x16_bf16 v[104:119], v[44:47], v[100:103], v[104:119]
  s_add_u32 s30, s30, 4096
  s_add_u32 s33, s33, 1
  s_cmp_lt_u32 s33, 64
  s_cbranch_scc1 fb_loop
  s_nop 7
  s_nop 7
attn_ok:
  v_mov_b32 v14, v116
  v_mov_b32 v15, v116
  s_nop 1
  v_permlane32_swap_b32 v14, v15
  s_nop 1
  v_rcp_f32 v10, v15
  s_nop 0
  v_pk_mul_f32 v[104:105], v[104:105], v[10:11] op_sel_hi:[1,0]
  v_pk_mul_f32 v[106:107], v[106:107], v[10:11] op_sel_hi:[1,0]
  v_pk_mul_f32 v[108:109], v[108:109], v[10:11] op_sel_hi:[1,0]
  v_pk_mul_f32 v[110:111], v[110:111], v[10:11] op_sel_hi:[1,0]
  v_pk_mul_f32 v[112:113], v[112:113], v[10:11] op_sel_hi:[1,0]
  v_pk_mul_f32 v[114:115], v[114:115], v[10:11] op_sel_hi:[1,0]
  v_pk_mul_f32 v[116:117], v[116:117], v[10:11] op_sel_hi:[1,0]
  v_pk_mul_f32 v[118:119], v[118:119], v[10:11] op_sel_hi:[1,0]
  v_cvt_pk_bf16_f32 v104, v104, v105
  v_cvt_pk_bf16_f32 v105, v106, v107
  v_cvt_pk_bf16_f32 v106, v108, v109
  v_cvt_pk_bf16_f32 v107, v110, v111
  v_cvt_pk_bf16_f32 v108, v112, v113
  v_cvt_pk_bf16_f32 v109, v114, v115
  v_cvt_pk_bf16_f32 v110, v116, v117
  v_cvt_pk_bf16_f32 v111, v118, v119
  s_lshl_b32 s30, s26, 5
  s_lshl_b32 s31, s27, 1
  s_add_u32 s30, s30, s31
  s_lshl_b32 s30, s30, 10
  s_add_u32 s30, s30, s20
  buffer_store_dwordx4 v[104:107], v4, s[4:7], s30 offen
  buffer_store_dwordx4 v[108:111], v4, s[4:7], s30 offen offset:1024
  s_waitcnt vmcnt(0) lgkmcnt(0)
  s_barrier
  s_add_u32 s15, s15, 1
  s_cmp_lg_u32 s3, 0
  s_cbranch_scc1 lb_end_7
  v_lshlrev_b32 v5, 2, v2
  s_lshl_b32 s40, s12, 7
  s_mov_b32 s42, 0
  s_cmp_lg_u32 s15, 1
  s_cbranch_scc1 lb_known_11
  s_add_u32 s41, s40, 0x4e0000
lb_px_12:
  s_add_u32 s42, s42, 1
  s_cmp_gt_u32 s42, 0x40000
  s_cbranch_scc1 lb_known_11
  buffer_load_dword v6, v5, s[4:7], s41 offen sc0 sc1
  s_waitcnt vmcnt(0)
  v_and_b32 v7, -16, v6
  v_cmp_ne_u32 vcc, s67, v7
  s_cbranch_vccnz lb_px_12
  v_readfirstlane_b32 s43, v6
  s_nop 1
  v_cmp_ne_u32 vcc, s43, v6
  s_mov_b32 s16, 0
  s_cbranch_vccnz lb_known_11
  s_mov_b32 s16, 1
lb_known_11:
  s_add_u32 s41, s40, 0x4e1000
  s_lshl_b32 s43, s13, 2
  s_add_u32 s43, s43, s41
  s_add_u32 s40, s67, s15
  v_mov_b32 v6, s40
  v_mov_b32 v7, 0
  s_mov_b32 s42, 0
  s_cmp_eq_u32 s16, 0
  s_cbranch_scc1 lb_slow_8
  s_mov_b64 exec, 1
  buffer_store_dword v6, v7, s[4:7], s43 offen
  s_mov_b64 exec, -1
lb_poll_9:
  s_add_u32 s42, s42, 1
  s_cmp_gt_u32 s42, 0x40000
  s_cbranch_scc1 lb_end_7
  buffer_load_dword v6, v5, s[4:7], s41 offen sc1
  s_waitcnt vmcnt(0)
  v_subrev_u32 v6, s40, v6
  v_cmp_le_u32 vcc, 8, v6
  s_cbranch_vccnz lb_poll_9
  s_branch lb_end_7
lb_slow_8:
  buffer_wbl2 sc1
  s_waitcnt vmcnt(0)
  s_mov_b64 exec, 1
  buffer_store_dword v6, v7, s[4:7], s43 offen sc0 sc1
  s_mov_b64 exec, -1
lb_poll2_10:
  s_add_u32 s42, s42, 1
  s_cmp_gt_u32 s42, 0x40000
  s_cbranch_scc1 lb_done_13
  buffer_load_dword v6, v5, s[4:7], s41 offen sc0 sc1
  s_waitcnt vmcnt(0)
  v_subrev_u32 v6, s40, v6
  v_cmp_le_u32 vcc, 8, v6
  s_cbranch_vccnz lb_poll2_10
lb_done_13:
  buffer_inv sc1
  s_waitcnt vmcnt(0)
lb_end_7:
  s_barrier
  s_cmp_ge_u32 s13, 28
  s_cbranch_scc1 wo_skip
  s_mul_i32 s30, s28, 65536
  s_mul_i32 s31, s3, 8192
  s_add_u32 s30, s30, s31
  s_add_u32 s30, s30, s20
  s_add_u32 s31, s30, 32768
  buffer_load_dwordx4 v[96:99], v4, s[4:7], s30 offen offset:0 sc1
  buffer_load_dwordx4 v[100:103], v4, s[4:7], s31 offen offset:0 sc1
  buffer_load_dwordx4 v[104:107], v4, s[4:7], s30 offen offset:1024 sc1
  buffer_load_dwordx4 v[108:111], v4, s[4:7], s31 offen offset:1024 sc1
  buffer_load_dwordx4 v[112:115], v4, s[4:7], s30 offen offset:2048 sc1
  buffer_load_dwordx4 v[116:119], v4, s[4:7], s31 offen offset:2048 sc1
  buffer_load_dwordx4 v[120:123], v4, s[4:7], s30 offen offset:3072 sc1
  buffer_load_dwordx4 v[124:127], v4, s[4:7], s31 offen offset:3072 sc1
  s_add_u32 s30, s30, 4096
  s_add_u32 s31, s31, 4096
  buffer_load_dwordx4 v[128:131], v4, s[4:7], s30 offen offset:0 sc1
  buffer_load_dwordx4 v[132:135], v4, s[4:7], s31 offen offset:0 sc1
  buffer_load_dwordx4 v[136:139], v4, s[4:7], s30 offen offset:1024 sc1
  buffer_load_dwordx4 v[140:143], v4, s[4:7], s31 offen offset:1024 sc1
  s_waitcnt vmcnt(10)
  v_mfma_f32_32x32x16_bf16 v[32:47], v[192:195], v[96:99], 0
  buffer_load_dwordx4 v[144:147], v4, s[4:7], s30 offen offset:2048 sc1
  v_mfma_f32_32x32x16_bf16 v[48:63], v[196:199], v[96:99], 0
  buffer_load_dwordx4 v[148:151], v4, s[4:7], s31 offen offset:2048 sc1
  v_mfma_f32_32x32x16_bf16 v[64:79], v[192:195], v[100:103], 0
  v_mfma_f32_32x32x16_bf16 v[80:95], v[196:199], v[100:103], 0
  s_waitcnt vmcnt(10)
  v_mfma_f32_32x32x16_bf16 v[32:47], v[200:203], v[104:107], v[32:47]
  buffer_load_dwordx4 v[152:155], v4, s[4:7], s30 offen offset:3072 sc1
  v_mfma_f32_32x32x16_bf16 v[48:63], v[204:207], v[104:107], v[48:63]
  buffer_load_dwordx4 v[156:159], v4, s[4:7], s31 offen offset:3072 sc1
  s_add_u32 s30, s30, 4096
  s_add_u32 s31, s31, 4096
  v_mfma_f32_32x32x16_bf16 v[64:79], v[200:203], v[108:111], v[64:79]
  v_mfma_f32_32x32x16_bf16 v[80:95], v[204:207], v[108:111], v[80:95]
  s_waitcnt vmcnt(10)
  v_mfma_f32_32x32x16_bf16 v[32:47], v[208:211], v[112:115], v[32:47]
  s_add_u32 s38, s37, s17
  buffer_load_dwordx4 v[16:19], v4, s[4:7], s38 offen sc1
  buffer_load_dwordx4 v[20:23], v4, s[4:7], s38 offen offset:1024 sc1
  v_mfma_f32_32x32x16_bf16 v[48:63], v[212:215], v[112:115], v[48:63]
  v_mfma_f32_32x32x16_bf16 v[64:79], v[208:211], v[116:119], v[64:79]
  v_mfma_f32_32x32x16_bf16 v[80:95], v[212:215], v[116:119], v[80:95]
  s_waitcnt vmcnt(10)
  v_mfma_f32_32x32x16_bf16 v[32:47], v[216:219], v[120:123], v[32:47]
  v_mfma_f32_32x32x16_bf16 v[48:63], v[220:223], v[120:123], v[48:63]
  v_mfma_f32_32x32x16_bf16 v[64:79], v[216:219], v[124:127], v[64:79]
  v_mfma_f32_32x32x16_bf16 v[80:95], v[220:223], v[124:127], v[80:95]
  s_waitcnt vmcnt(8)
  v_mfma_f32_32x32x16_bf16 v[32:47], v[224:227], v[128:131], v[32:47]
  v_mfma_f32_32x32x16_bf16 v[48:63], v[228:231], v[128:131], v[48:63]
  v_mfma_f32_32x32x16_bf16 v[64:79], v[224:227], v[132:135], v[64:79]
  v_mfma_f32_32x32x16_bf16 v[80:95], v[228:231], v[132:135], v[80:95]
  s_waitcnt vmcnt(6)
  v_mfma_f32_32x32x16_bf16 v[32:47], v[232:235], v[136:139], v[32:47]
  v_mfma_f32_32x32x16_bf16 v[48:63], v[236:239], v[136:139], v[48:63]
  v_mfma_f32_32x32x16_bf16 v[64:79], v[232:235], v[140:143], v[64:79]
  v_mfma_f32_32x32x16_bf16 v[80:95], v[236:239], v[140:143], v[80:95]
  s_waitcnt vmcnt(4)
  v_mfma_f32_32x32x16_bf16 v[32:47], v[240:243], v[144:147], v[32:47]
  v_mfma_f32_32x32x16_bf16 v[48:63], v[244:247], v[144:147], v[48:63]
  v_mfma_f32_32x32x16_bf16 v[64:79], v[240:243], v[148:151], v[64:79]
  v_mfma_f32_32x32x16_bf16 v[80:95], v[244:247], v[148:151], v[80:95]
  s_waitcnt vmcnt(2)
  v_mfma_f32_32x32x16_bf16 v[32:47], v[248:251], v[152:155], v[32:47]
  v_mfma_f32_32x32x16_bf16 v[48:63], v[252:255], v[152:155], v[48:63]
  v_mfma_f32_32x32x16_bf16 v[64:79], v[248:251], v[156:159], v[64:79]
  v_mfma_f32_32x32x16_bf16 v[80:95], v[252:255], v[156:159], v[80:95]
  s_nop 7
  s_nop 7
  v_add_u32 v5, 114688, v4
  s_cmp_eq_u32 s3, 0
  s_cbranch_scc1 red_15
  s_cmp_eq_u32 s3, 1
  s_cbranch_scc1 red_16
  s_cmp_eq_u32 s3, 2
  s_cbranch_scc1 red_17
  ds_write_b128 v5, v[32:35] offset:8192
  ds_write_b128 v5, v[36:39] offset:9216
  ds_write_b128 v5, v[40:43] offset:10240
  ds_write_b128 v5, v[44:47] offset:11264
  ds_write_b128 v5, v[48:51] offset:16384
  ds_write_b128 v5, v[52:55] offset:17408
  ds_write_b128 v5, v[56:59] offset:18432
  ds_write_b128 v5, v[60:63] offset:19456
  ds_write_b128 v5, v[64:67] offset:24576
  ds_write_b128 v5, v[68:71] offset:25600
  ds_write_b128 v5, v[72:75] offset:26624
  ds_write_b128 v5, v[76:79] offset:27648
  s_waitcnt lgkmcnt(0)
  v_mov_b32 v32, v80
  v_mov_b32 v33, v81
  v_mov_b32 v34, v82
  v_mov_b32 v35, v83
  v_mov_b32 v36, v84
  v_mov_b32 v37, v85
  v_mov_b32 v38, v86
  v_mov_b32 v39, v87
  v_mov_b32 v40, v88
  v_mov_b32 v41, v89
  v_mov_b32 v42, v90
  v_mov_b32 v43, v91
  v_mov_b32 v44, v92
  v_mov_b32 v45, v93
  v_mov_b32 v46, v94
  v_mov_b32 v47, v95
  s_branch redj_14
red_15:
  ds_write_b128 v5, v[48:51] offset:20480
  ds_write_b128 v5, v[52:55] offset:21504
  ds_write_b128 v5, v[56:59] offset:22528
  ds_write_b128 v5, v[60:63] offset:23552
  ds_write_b128 v5, v[64:67] offset:28672
  ds_write_b128 v5, v[68:71] offset:29696
  ds_write_b128 v5, v[72:75] offset:30720
  ds_write_b128 v5, v[76:79] offset:31744
  ds_write_b128 v5, v[80:83] offset:36864
  ds_write_b128 v5, v[84:87] offset:37888
  ds_write_b128 v5, v[88:91] offset:38912
  ds_write_b128 v5, v[92:95] offset:39936
  s_branch redj_14
red_16:
  ds_write_b128 v5, v[32:35] offset:0
  ds_write_b128 v5, v[36:39] offset:1024
  ds_write_b128 v5, v[40:43] offset:2048
  ds_write_b128 v5, v[44:47] offset:3072
  ds_write_b128 v5, v[64:67] offset:32768
  ds_write_b128 v5, v[68:71] offset:33792
  ds_write_b128 v5, v[72:75] offset:34816
  ds_write_b128 v5, v[76:79] offset:35840
  ds_write_b128 v5, v[80:83] offset:40960
  ds_write_b128 v5, v[84:87] offset:41984
  ds_write_b128 v5, v[88:91] offset:43008
  ds_write_b128 v5, v[92:95] offset:44032
  s_waitcnt lgkmcnt(0)
  v_mov_b32 v32, v48
  v_mov_b32 v33, v49
  v_mov_b32 v34, v50
  v_mov_b32 v35, v51
  v_mov_b32 v36, v52
  v_mov_b32 v37, v53
  v_mov_b32 v38, v54
  v_mov_b32 v39, v55
  v_mov_b32 v40, v56
  v_mov_b32 v41, v57
  v_mov_b32 v42, v58
  v_mov_b32 v43, v59
  v_mov_b32 v44, v60
  v_mov_b32 v45, v61
  v_mov_b32 v46, v62
  v_mov_b32 v47, v63
  s_branch redj_14
red_17:
  ds_write_b128 v5, v[32:35] offset:4096
  ds_write_b128 v5, v[36:39] offset:5120
  ds_write_b128 v5, v[40:43] offset:6144
  ds_write_b128 v5, v[44:47] offset:7168
  ds_write_b128 v5, v[48:51] offset:12288
  ds_write_b128 v5, v[52:55] offset:13312
  ds_write_b128 v5, v[56:59] offset:14336
  ds_write_b128 v5, v[60:63] offset:15360
  ds_write_b128 v5, v[80:83] offset:45056
  ds_write_b128 v5, v[84:87] offset:46080
  ds_write_b128 v5, v[88:91] offset:47104
  ds_write_b128 v5, v[92:95] offset:48128
  s_waitcnt lgkmcnt(0)
  v_mov_b32 v32, v64
  v_mov_b32 v33, v65
  v_mov_b32 v34, v66
  v_mov_b32 v35, v67
  v_mov_b32 v36, v68
  v_mov_b32 v37, v69
  v_mov_b32 v38, v70
  v_mov_b32 v39, v71
  v_mov_b32 v40, v72
  v_mov_b32 v41, v73
  v_mov_b32 v42, v74
  v_mov_b32 v43, v75
  v_mov_b32 v44, v76
  v_mov_b32 v45, v77
  v_mov_b32 v46, v78
  v_mov_b32 v47, v79
redj_14:
  s_mul_i32 s30, s3, 12288
  v_add_u32 v5, s30, v5
  s_waitcnt lgkmcnt(0)
  s_barrier
  ds_read_b128 v[96:99], v5 offset:0
  ds_read_b128 v[100:103], v5 offset:1024
  ds_read_b128 v[104:107], v5 offset:2048
  ds_read_b128 v[108:111], v5 offset:3072
  ds_read_b128 v[112:115], v5 offset:4096
  ds_read_b128 v[116:119], v5 offset:5120
  ds_read_b128 v[120:123], v5 offset:6144
  ds_read_b128 v[124:127], v5 offset:7168
  ds_read_b128 v[128:131], v5 offset:8192
  ds_read_b128 v[132:135], v5 offset:9216
  ds_read_b128 v[136:139], v5 offset:10240
  ds_read_b128 v[140:143], v5 offset:11264
  s_waitcnt lgkmcnt(8)
  v_pk_add_f32 v[32:33], v[32:33], v[96:97]
  v_pk_add_f32 v[34:35], v[34:35], v[98:99]
  v_pk_add_f32 v[36:37], v[36:37], v[100:101]
  v_pk_add_f32 v[38:39], v[38:39], v[102:103]
  v_pk_add_f32 v[40:41], v[40:41], v[104:105]
  v_pk_add_f32 v[42:43], v[42:43], v[106:107]
  v_pk_add_f32 v[44:45], v[44:45], v[108:109]
  v_pk_add_f32 v[46:47], v[46:47], v[110:111]
  s_waitcnt lgkmcnt(4)
  v_pk_add_f32 v[32:33], v[32:33], v[112:113]
  v_pk_add_f32 v[34:35], v[34:35], v[114:115]
  v_pk_add_f32 v[36:37], v[36:37], v[116:117]
  v_pk_add_f32 v[38:39], v[38:39], v[118:119]
  v_pk_add_f32 v[40:41], v[40:41], v[120:121]
  v_pk_add_f32 v[42:43], v[42:43], v[122:123]
  v_pk_add_f32 v[44:45], v[44:45], v[124:125]
  v_pk_add_f32 v[46:47], v[46:47], v[126:127]
  s_waitcnt lgkmcnt(0)
  v_pk_add_f32 v[32:33], v[32:33], v[128:129]
  v_pk_add_f32 v[34:35], v[34:35], v[130:131]
  v_pk_add_f32 v[36:37], v[36:37], v[132:133]
  v_pk_add_f32 v[38:39], v[38:39], v[134:135]
  v_pk_add_f32 v[40:41], v[40:41], v[136:137]
  v_pk_add_f32 v[42:43], v[42:43], v[138:139]
  v_pk_add_f32 v[44:45], v[44:45], v[140:141]
  v_pk_add_f32 v[46:47], v[46:47], v[142:143]
  s_waitcnt vmcnt(0)
  v_lshlrev_b32 v96, 16, v16
  v_and_b32 v97, 0xffff0000, v16
  v_lshlrev_b32 v98, 16, v17
  v_and_b32 v99, 0xffff0000, v17
  v_lshlrev_b32 v100, 16, v18
  v_and_b32 v101, 0xffff0000, v18
  v_lshlrev_b32 v102, 16, v19
  v_and_b32 v103, 0xffff0000, v19
  v_lshlrev_b32 v104, 16, v20
  v_and_b32 v105, 0xffff0000, v20
  v_lshlrev_b32 v106, 16, v21
  v_and_b32 v107, 0xffff0000, v21
  v_lshlrev_b32 v108, 16, v22
  v_and_b32 v109, 0xffff0000, v22
  v_lshlrev_b32 v110, 16, v23
  v_and_b32 v111, 0xffff0000, v23
  v_pk_add_f32 v[32:33], v[32:33], v[96:97]
  v_pk_add_f32 v[34:35], v[34:35], v[98:99]
  v_pk_add_f32 v[36:37], v[36:37], v[100:101]
  v_pk_add_f32 v[38:39], v[38:39], v[102:103]
  v_pk_add_f32 v[40:41], v[40:41], v[104:105]
  v_pk_add_f32 v[42:43], v[42:43], v[106:107]
  v_pk_add_f32 v[44:45], v[44:45], v[108:109]
  v_pk_add_f32 v[46:47], v[46:47], v[110:111]
  v_pk_add_f32 v[96:97], v[32:33], v[34:35]
  v_pk_mul_f32 v[98:99], v[32:33], v[32:33]
  v_pk_fma_f32 v[98:99], v[34:35], v[34:35], v[98:99]
  v_pk_add_f32 v[96:97], v[96:97], v[36:37]
  v_pk_fma_f32 v[98:99], v[36:37], v[36:37], v[98:99]
  v_pk_add_f32 v[96:97], v[96:97], v[38:39]
  v_pk_fma_f32 v[98:99], v[38:39], v[38:39], v[98:99]
  v_pk_add_f32 v[96:97], v[96:97], v[40:41]
  v_pk_fma_f32 v[98:99], v[40:41], v[40:41], v[98:99]
  v_pk_add_f32 v[96:97], v[96:97], v[42:43]
  v_pk_fma_f32 v[98:99], v[42:43], v[42:43], v[98:99]
  v_pk_add_f32 v[96:97], v[96:97], v[44:45]
  v_pk_fma_f32 v[98:99], v[44:45], v[44:45], v[98:99]
  v_pk_add_f32 v[96:97], v[96:97], v[46:47]
  v_pk_fma_f32 v[98:99], v[46:47], v[46:47], v[98:99]
  v_add_f32 v100, v96, v97
  v_add_f32 v101, v98, v99
  v_mov_b32 v102, v100
  v_mov_b32 v103, v101
  v_cvt_pk_bf16_f32 v32, v32, v33
  v_cvt_pk_bf16_f32 v33, v34, v35
  v_cvt_pk_bf16_f32 v34, v36, v37
  v_cvt_pk_bf16_f32 v35, v38, v39
  v_cvt_pk_bf16_f32 v36, v40, v41
  v_cvt_pk_bf16_f32 v37, v42, v43
  v_cvt_pk_bf16_f32 v38, v44, v45
  v_cvt_pk_bf16_f32 v39, v46, v47
  s_add_u32 s38, s37, s21
  buffer_store_dwordx4 v[32:35], v4, s[4:7], s38 offen
  buffer_store_dwordx4 v[36:39], v4, s[4:7], s38 offen offset:1024
  v_permlane32_swap_b32 v100, v102
  v_permlane32_swap_b32 v101, v103
  v_lshlrev_b32 v5, 3, v2
  s_lshl_b32 s38, s36, 14
  s_lshl_b32 s39, s35, 8
  s_add_u32 s38, s38, s39
  s_add_u32 s38, s38, s22
  v_add_f32 v100, v100, v102
  v_add_f32 v101, v101, v103
  buffer_store_dwordx2 v[100:101], v5, s[4:7], s38 offen
wo_skip:
  s_waitcnt vmcnt(0) lgkmcnt(0)
  s_barrier
  s_add_u32 s15, s15, 1
  s_cmp_lg_u32 s3, 0
  s_cbranch_scc1 lb_end_21
  v_lshlrev_b32 v5, 2, v2
  s_lshl_b32 s40, s12, 7
  s_mov_b32 s42, 0
  s_cmp_lg_u32 s15, 1
  s_cbranch_scc1 lb_known_25
  s_add_u32 s41, s40, 0x4e0000
lb_px_26:
  s_add_u32 s42, s42, 1
  s_cmp_gt_u32 s42, 0x40000
  s_cbranch_scc1 lb_known_25
  buffer_load_dword v6, v5, s[4:7], s41 offen sc0 sc1
  s_waitcnt vmcnt(0)
  v_and_b32 v7, -16, v6
  v_cmp_ne_u32 vcc, s67, v7
  s_cbranch_vccnz lb_px_26
  v_readfirstlane_b32 s43, v6
  s_nop 1
  v_cmp_ne_u32 vcc, s43, v6
  s_mov_b32 s16, 0
  s_cbranch_vccnz lb_known_25
  s_mov_b32 s16, 1
lb_known_25:
  s_add_u32 s41, s40, 0x4e1000
  s_lshl_b32 s43, s13, 2
  s_add_u32 s43, s43, s41
  s_add_u32 s40, s67, s15
  v_mov_b32 v6, s40
  v_mov_b32 v7, 0
  s_mov_b32 s42, 0
  s_cmp_eq_u32 s16, 0
  s_cbranch_scc1 lb_slow_22
  s_mov_b64 exec, 1
  buffer_store_dword v6, v7, s[4:7], s43 offen
  s_mov_b64 exec, -1
lb_poll_23:
  s_add_u32 s42, s42, 1
  s_cmp_gt_u32 s42, 0x40000
  s_cbranch_scc1 lb_end_21
  buffer_load_dword v6, v5, s[4:7], s41 offen sc1
  s_waitcnt vmcnt(0)
  v_subrev_u32 v6, s40, v6
  v_cmp_le_u32 vcc, 8, v6
  s_cbranch_vccnz lb_poll_23
  s_branch lb_end_21
lb_slow_22:
  buffer_wbl2 sc1
  s_waitcnt vmcnt(0)
  s_mov_b64 exec, 1
  buffer_store_dword v6, v7, s[4:7], s43 offen sc0 sc1
  s_mov_b64 exec, -1
lb_poll2_24:
  s_add_u32 s42, s42, 1
  s_cmp_gt_u32 s42, 0x40000
  s_cbranch_scc1 lb_done_27
  buffer_load_dword v6, v5, s[4:7], s41 offen sc0 sc1
  s_waitcnt vmcnt(0)
  v_subrev_u32 v6, s40, v6
  v_cmp_le_u32 vcc, 8, v6
  s_cbranch_vccnz lb_poll2_24
lb_done_27:
  buffer_inv sc1
  s_waitcnt vmcnt(0)
lb_end_21:
  s_barrier
  s_cmp_ge_u32 s13, 28
  s_cbranch_scc1 ffn1_skip
  s_mul_i32 s30, s26, 28672
  s_add_u32 s30, s30, s21
  buffer_load_dwordx4 v[16:19], v4, s[4:7], s30 offen offset:0 sc1
  buffer_load_dwordx4 v[20:23], v4, s[4:7], s30 offen offset:1024 sc1
  buffer_load_dwordx4 v[24:27], v4, s[4:7], s30 offen offset:2048 sc1
  buffer_load_dwordx4 v[28:31], v4, s[4:7], s30 offen offset:3072 sc1
  s_add_u32 s30, s30, 4096
  buffer_load_dwordx4 v[32:35], v4, s[4:7], s30 offen offset:0 sc1
  buffer_load_dwordx4 v[36:39], v4, s[4:7], s30 offen offset:1024 sc1
  buffer_load_dwordx4 v[40:43], v4, s[4:7], s30 offen offset:2048 sc1
  v_lshlrev_b32 v6, 4, v3
  s_lshl_b32 s48, s27, 9
  s_add_u32 s48, s48, 0x4d2000
  v_mul_u32_u24 v9, 7680, v3
  v_add_u32 v9, v9, v4
  s_lshl_b32 s49, s3, 10
  s_add_u32 s49, s49, 114688
  v_add_u32 v8, 0x10000, v4
  ds_read_b128 v[192:195], v4 offset:0
  ds_read_b128 v[196:199], v4 offset:1024
  ds_read_b128 v[200:203], v4 offset:2048
  ds_read_b128 v[204:207], v4 offset:3072
  ds_read_b128 v[208:211], v4 offset:4096
  ds_read_b128 v[212:215], v4 offset:5120
  ds_read_b128 v[216:219], v4 offset:6144
  ds_read_b128 v[220:223], v4 offset:7168
  s_waitcnt vmcnt(6)
  s_waitcnt lgkmcnt(4)
  v_mfma_f32_32x32x16_bf16 v[128:143], v[192:195], v[16:19], 0
  ds_read_b128 v[224:227], v4 offset:8192
  buffer_load_dwordx4 v[44:47], v4, s[4:7], s30 offen offset:3072 sc1
  s_add_u32 s30, s30, 4096
  v_mfma_f32_32x32x16_bf16 v[144:159], v[196:199], v[16:19], 0
  ds_read_b128 v[228:231], v4 offset:9216
  v_mfma_f32_32x32x16_bf16 v[160:175], v[200:203], v[16:19], 0
  ds_read_b128 v[232:235], v4 offset:10240
  buffer_load_dwordx4 v[48:51], v4, s[4:7], s30 offen offset:0 sc1
  v_mfma_f32_32x32x16_bf16 v[176:191], v[204:207], v[16:19], 0
  ds_read_b128 v[236:239], v4 offset:11264
  s_waitcnt vmcnt(7)
  s_waitcnt lgkmcnt(4)
  v_mfma_f32_32x32x16_bf16 v[128:143], v[208:211], v[20:23], v[128:143]
  ds_read_b128 v[192:195], v4 offset:12288
  buffer_load_dwordx4 v[52:55], v4, s[4:7], s30 offen offset:1024 sc1
  v_mfma_f32_32x32x16_bf16 v[144:159], v[212:215], v[20:23], v[144:159]
  ds_read_b128 v[196:199], v4 offset:13312
  v_mfma_f32_32x32x16_bf16 v[160:175], v[216:219], v[20:23], v[160:175]
  ds_read_b128 v[200:203], v4 offset:14336
  buffer_load_dwordx4 v[56:59], v4, s[4:7], s30 offen offset:2048 sc1
  v_mfma_f32_32x32x16_bf16 v[176:191], v[220:223], v[20:23], v[176:191]
  ds_read_b128 v[204:207], v4 offset:15360
  s_waitcnt vmcnt(8)
  s_waitcnt lgkmcnt(4)
  v_mfma_f32_32x32x16_bf16 v[128:143], v[224:227], v[24:27], v[128:143]
  ds_read_b128 v[208:211], v4 offset:16384
  buffer_load_dwordx4 v[60:63], v4, s[4:7], s30 offen offset:3072 sc1
  s_add_u32 s30, s30, 4096
  v_mfma_f32_32x32x16_bf16 v[144:159], v[228:231], v[24:27], v[144:159]
  ds_read_b128 v[212:215], v4 offset:17408
  v_mfma_f32_32x32x16_bf16 v[160:175], v[232:235], v[24:27], v[160:175]
  ds_read_b128 v[216:219], v4 offset:18432
  buffer_load_dwordx4 v[64:67], v4, s[4:7], s30 offen offset:0 sc1
  v_mfma_f32_32x32x16_bf16 v[176:191], v[236:239], v[24:27], v[176:191]
  ds_read_b128 v[220:223], v4 offset:19456
  s_waitcnt vmcnt(9)
  s_waitcnt lgkmcnt(4)
  v_mfma_f32_32x32x16_bf16 v[128:143], v[192:195], v[28:31], v[128:143]
  ds_read_b128 v[224:227], v4 offset:20480
  buffer_load_dwordx4 v[68:71], v4, s[4:7], s30 offen offset:1024 sc1
  v_mfma_f32_32x32x16_bf16 v[144:159], v[196:199], v[28:31], v[144:159]
  ds_read_b128 v[228:231], v4 offset:21504
  v_mfma_f32_32x32x16_bf16 v[160:175], v[200:203], v[28:31], v[160:175]
  ds_read_b128 v[232:235], v4 offset:22528
  buffer_load_dwordx4 v[72:75], v4, s[4:7], s30 offen offset:2048 sc1
  v_mfma_f32_32x32x16_bf16 v[176:191], v[204:207], v[28:31], v[176:191]
  ds_read_b128 v[236:239], v4 offset:23552
  s_waitcnt vmcnt(10)
  s_waitcnt lgkmcnt(4)
  v_mfma_f32_32x32x16_bf16 v[128:143], v[208:211], v[32:35], v[128:143]
  ds_read_b128 v[192:195], v4 offset:24576
  buffer_load_dwordx4 v[76:79], v4, s[4:7], s30 offen offset:3072 sc1
  s_add_u32 s30, s30, 4096
  v_mfma_f32_32x32x16_bf16 v[144:159], v[212:215], v[32:35], v[144:159]
  ds_read_b128 v[196:199], v4 offset:25600
  v_mfma_f32_32x32x16_bf16 v[160:175], v[216:219], v[32:35], v[160:175]
  ds_read_b128 v[200:203], v4 offset:26624
  buffer_load_dwordx4 v[80:83], v4, s[4:7], s30 offen offset:0 sc1
  v_mfma_f32_32x32x16_bf16 v[176:191], v[220:223], v[32:35], v[176:191]
  ds_read_b128 v[204:207], v4 offset:27648
  s_waitcnt vmcnt(11)
  s_waitcnt lgkmcnt(4)
  v_mfma_f32_32x32x16_bf16 v[128:143], v[224:227], v[36:39], v[128:143]
  ds_read_b128 v[208:211], v4 offset:28672
  buffer_load_dwordx4 v[84:87], v4, s[4:7], s30 offen offset:1024 sc1
  v_mfma_f32_32x32x16_bf16 v[144:159], v[228:231], v[36:39], v[144:159]
  ds_read_b128 v[212:215], v4 offset:29696
  v_mfma_f32_32x32x16_bf16 v[160:175], v[232:235], v[36:39], v[160:175]
  ds_read_b128 v[216:219], v4 offset:30720
  buffer_load_dwordx4 v[88:91], v4, s[4:7], s30 offen offset:2048 sc1
  v_mfma_f32_32x32x16_bf16 v[176:191], v[236:239], v[36:39], v[176:191]
  ds_read_b128 v[220:223], v4 offset:31744
  s_waitcnt vmcnt(12)
  s_waitcnt lgkmcnt(4)
  v_mfma_f32_32x32x16_bf16 v[128:143], v[192:195], v[40:43], v[128:143]
  ds_read_b128 v[224:227], v4 offset:32768
  buffer_load_dwordx4 v[92:95], v4, s[4:7], s30 offen offset:3072 sc1
  s_add_u32 s30, s30, 4096
  v_mfma_f32_32x32x16_bf16 v[144:159], v[196:199], v[40:43], v[144:159]
  ds_read_b128 v[228:231], v4 offset:33792
  v_mfma_f32_32x32x16_bf16 v[160:175], v[200:203], v[40:43], v[160:175]
  ds_read_b128 v[232:235], v4 offset:34816
  buffer_load_dwordx4 v[96:99], v4, s[4:7], s30 offen offset:0 sc1
  v_mfma_f32_32x32x16_bf16 v[176:191], v[204:207], v[40:43], v[176:191]
  ds_read_b128 v[236:239], v4 offset:35840
  s_waitcnt vmcnt(13)
  s_waitcnt lgkmcnt(4)
  v_mfma_f32_32x32x16_bf16 v[128:143], v[208:211], v[44:47], v[128:143]
  ds_read_b128 v[192:195], v4 offset:36864
  buffer_load_dwordx4 v[100:103], v4, s[4:7], s30 offen offset:1024 sc1
  v_mfma_f32_32x32x16_bf16 v[144:159], v[212:215], v[44:47], v[144:159]
  ds_read_b128 v[196:199], v4 offset:37888
  v_mfma_f32_32x32x16_bf16 v[160:175], v[216:219], v[44:47], v[160:175]
  ds_read_b128 v[200:203], v4 offset:38912
  buffer_load_dwordx4 v[104:107], v4, s[4:7], s30 offen offset:2048 sc1
  v_mfma_f32_32x32x16_bf16 v[176:191], v[220:223], v[44:47], v[176:191]
  ds_read_b128 v[204:207], v4 offset:39936
  s_waitcnt vmcnt(14)
  s_waitcnt lgkmcnt(4)
  v_mfma_f32_32x32x16_bf16 v[128:143], v[224:227], v[48:51], v[128:143]
  ds_read_b128 v[208:211], v4 offset:40960
  buffer_load_dwordx4 v[108:111], v4, s[4:7], s30 offen offset:3072 sc1
  s_add_u32 s30, s30, 4096
  v_mfma_f32_32x32x16_bf16 v[144:159], v[228:231], v[48:51], v[144:159]
  ds_read_b128 v[212:215], v4 offset:41984
  v_mfma_f32_32x32x16_bf16 v[160:175], v[232:235], v[48:51], v[160:175]
  ds_read_b128 v[216:219], v4 offset:43008
  buffer_load_dwordx4 v[112:115], v4, s[4:7], s30 offen offset:0 sc1
  v_mfma_f32_32x32x16_bf16 v[176:191], v[236:239], v[48:51], v[176:191]
  ds_read_b128 v[220:223], v4 offset:44032
  s_waitcnt vmcnt(15)
  s_waitcnt lgkmcnt(4)
  v_mfma_f32_32x32x16_bf16 v[128:143], v[192:195], v[52:55], v[128:143]
  ds_read_b128 v[224:227], v4 offset:45056
  buffer_load_dwordx4 v[116:119], v4, s[4:7], s30 offen offset:1024 sc1
  v_mfma_f32_32x32x16_bf16 v[144:159], v[196:199], v[52:55], v[144:159]
  ds_read_b128 v[228:231], v4 offset:46080
  v_mfma_f32_32x32x16_bf16 v[160:175], v[200:203], v[52:55], v[160:175]
  ds_read_b128 v[232:235], v4 offset:47104
  buffer_load_dwordx4 v[120:123], v4, s[4:7], s30 offen offset:2048 sc1
  v_mfma_f32_32x32x16_bf16 v[176:191], v[204:207], v[52:55], v[176:191]
  ds_read_b128 v[236:239], v4 offset:48128
  s_waitcnt vmcnt(16)
  s_waitcnt lgkmcnt(4)
  v_mfma_f32_32x32x16_bf16 v[128:143], v[208:211], v[56:59], v[128:143]
  ds_read_b128 v[192:195], v4 offset:49152
  buffer_load_dwordx4 v[124:127], v4, s[4:7], s30 offen offset:3072 sc1
  v_mfma_f32_32x32x16_bf16 v[144:159], v[212:215], v[56:59], v[144:159]
  ds_read_b128 v[196:199], v4 offset:50176
  v_mfma_f32_32x32x16_bf16 v[160:175], v[216:219], v[56:59], v[160:175]
  ds_read_b128 v[200:203], v4 offset:51200
  v_mul_u32_u24 v5, 114688, v3
  v_lshl_add_u32 v5, v2, 3, v5
  s_lshl_b32 s31, s26, 8
  s_add_u32 s31, s31, s22
  buffer_load_dwordx2 v[240:241], v5, s[4:7], s31 offen sc1
  s_add_u32 s31, s31, 16384
  buffer_load_dwordx2 v[242:243], v5, s[4:7], s31 offen sc1
  s_add_u32 s31, s31, 16384
  buffer_load_dwordx2 v[244:245], v5, s[4:7], s31 offen sc1
  s_add_u32 s31, s31, 16384
  buffer_load_dwordx2 v[246:247], v5, s[4:7], s31 offen sc1
  s_add_u32 s31, s31, 16384
  buffer_load_dwordx2 v[248:249], v5, s[4:7], s31 offen sc1
  s_add_u32 s31, s31, 16384
  buffer_load_dwordx2 v[250:251], v5, s[4:7], s31 offen sc1
  s_add_u32 s31, s31, 16384
  buffer_load_dwordx2 v[252:253], v5, s[4:7], s31 offen sc1
  v_mfma_f32_32x32x16_bf16 v[176:191], v[220:223], v[56:59], v[176:191]
  ds_read_b128 v[204:207], v4 offset:52224
  s_waitcnt vmcnt(23)
  s_waitcnt lgkmcnt(4)
  v_mfma_f32_32x32x16_bf16 v[128:143], v[224:227], v[60:63], v[128:143]
  ds_read_b128 v[208:211], v4 offset:53248
  v_mfma_f32_32x32x16_bf16 v[144:159], v[228:231], v[60:63], v[144:159]
  ds_read_b128 v[212:215], v4 offset:54272
  v_mfma_f32_32x32x16_bf16 v[160:175], v[232:235], v[60:63], v[160:175]
  ds_read_b128 v[216:219], v4 offset:55296
  s_mov_b32 m0, s49
  s_nop 0
  buffer_load_dwordx4 v9, s[4:7], s48 offen lds
  v_mfma_f32_32x32x16_bf16 v[176:191], v[236:239], v[60:63], v[176:191]
  ds_read_b128 v[220:223], v4 offset:56320
  s_waitcnt vmcnt(23)
  s_waitcnt lgkmcnt(4)
  v_mfma_f32_32x32x16_bf16 v[128:143], v[192:195], v[64:67], v[128:143]
  ds_read_b128 v[224:227], v4 offset:57344
  buffer_load_dwordx4 a[160:163], v4, s[4:7], s46 offen offset:0
  v_mfma_f32_32x32x16_bf16 v[144:159], v[196:199], v[64:67], v[144:159]
  ds_read_b128 v[228:231], v4 offset:58368
  v_mfma_f32_32x32x16_bf16 v[160:175], v[200:203], v[64:67], v[160:175]
  ds_read_b128 v[232:235], v4 offset:59392
  v_mfma_f32_32x32x16_bf16 v[176:191], v[204:207], v[64:67], v[176:191]
  ds_read_b128 v[236:239], v4 offset:60416
  s_waitcnt vmcnt(23)
  s_waitcnt lgkmcnt(4)
  v_mfma_f32_32x32x16_bf16 v[128:143], v[208:211], v[68:71], v[128:143]
  ds_read_b128 v[192:195], v4 offset:61440
  buffer_load_dwordx4 a[164:167], v4, s[4:7], s47 offen offset:0
  v_mfma_f32_32x32x16_bf16 v[144:159], v[212:215], v[68:71], v[144:159]
  ds_read_b128 v[196:199], v4 offset:62464
  v_mfma_f32_32x32x16_bf16 v[160:175], v[216:219], v[68:71], v[160:175]
  ds_read_b128 v[200:203], v4 offset:63488
  v_mfma_f32_32x32x16_bf16 v[176:191], v[220:223], v[68:71], v[176:191]
  ds_read_b128 v[204:207], v4 offset:64512
  s_waitcnt vmcnt(23)
  s_waitcnt lgkmcnt(4)
  v_mfma_f32_32x32x16_bf16 v[128:143], v[224:227], v[72:75], v[128:143]
  ds_read_b128 v[208:211], v8 offset:0
  buffer_load_dwordx4 a[168:171], v4, s[4:7], s46 offen offset:1024
  v_mfma_f32_32x32x16_bf16 v[144:159], v[228:231], v[72:75], v[144:159]
  ds_read_b128 v[212:215], v8 offset:1024
  v_mfma_f32_32x32x16_bf16 v[160:175], v[232:235], v[72:75], v[160:175]
  ds_read_b128 v[216:219], v8 offset:2048
  v_mfma_f32_32x32x16_bf16 v[176:191], v[236:239], v[72:75], v[176:191]
  ds_read_b128 v[220:223], v8 offset:3072
  s_waitcnt vmcnt(23)
  s_waitcnt lgkmcnt(4)
  v_mfma_f32_32x32x16_bf16 v[128:143], v[192:195], v[76:79], v[128:143]
  ds_read_b128 v[224:227], v8 offset:4096
  buffer_load_dwordx4 a[172:175], v4, s[4:7], s47 offen offset:1024
  v_mfma_f32_32x32x16_bf16 v[144:159], v[196:199], v[76:79], v[144:159]
  ds_read_b128 v[228:231], v8 offset:5120
  v_mfma_f32_32x32x16_bf16 v[160:175], v[200:203], v[76:79], v[160:175]
  ds_read_b128 v[232:235], v8 offset:6144
  v_mfma_f32_32x32x16_bf16 v[176:191], v[204:207], v[76:79], v[176:191]
  ds_read_b128 v[236:239], v8 offset:7168
  s_waitcnt vmcnt(23)
  s_waitcnt lgkmcnt(4)
  v_mfma_f32_32x32x16_bf16 v[128:143], v[208:211], v[80:83], v[128:143]
  ds_read_b128 v[192:195], v8 offset:8192
  buffer_load_dwordx4 a[176:179], v4, s[4:7], s46 offen offset:2048
  s_waitcnt vmcnt(6)
  v_mfma_f32_32x32x16_bf16 v[144:159], v[212:215], v[80:83], v[144:159]
  ds_read_b128 v[196:199], v8 offset:9216
  v_add_f32 v240, v240, v242
  v_add_f32 v241, v241, v243
  v_mfma_f32_32x32x16_bf16 v[160:175], v[216:219], v[80:83], v[160:175]
  ds_read_b128 v[200:203], v8 offset:10240
  v_mfma_f32_32x32x16_bf16 v[176:191], v[220:223], v[80:83], v[176:191]
  ds_read_b128 v[204:207], v8 offset:11264
  v_add_f32 v240, v240, v244
  v_add_f32 v241, v241, v245
  s_waitcnt vmcnt(23)
  s_waitcnt lgkmcnt(4)
  v_mfma_f32_32x32x16_bf16 v[128:143], v[224:227], v[84:87], v[128:143]
  ds_read_b128 v[208:211], v8 offset:12288
  buffer_load_dwordx4 a[180:183], v4, s[4:7], s47 offen offset:2048
  v_mfma_f32_32x32x16_bf16 v[144:159], v[228:231], v[84:87], v[144:159]
  ds_read_b128 v[212:215], v8 offset:13312
  v_add_f32 v240, v240, v246
  v_add_f32 v241, v241, v247
  v_mfma_f32_32x32x16_bf16 v[160:175], v[232:235], v[84:87], v[160:175]
  ds_read_b128 v[216:219], v8 offset:14336
  v_mfma_f32_32x32x16_bf16 v[176:191], v[236:239], v[84:87], v[176:191]
  ds_read_b128 v[220:223], v8 offset:15360
  v_add_f32 v240, v240, v248
  v_add_f32 v241, v241, v249
  s_waitcnt vmcnt(23)
  s_waitcnt lgkmcnt(4)
  v_mfma_f32_32x32x16_bf16 v[128:143], v[192:195], v[88:91], v[128:143]
  ds_read_b128 v[224:227], v8 offset:16384
  buffer_load_dwordx4 a[184:187], v4, s[4:7], s46 offen offset:3072
  v_mfma_f32_32x32x16_bf16 v[144:159], v[196:199], v[88:91], v[144:159]
  ds_read_b128 v[228:231], v8 offset:17408
  v_add_f32 v240, v240, v250
  v_add_f32 v241, v241, v251
  v_mfma_f32_32x32x16_bf16 v[160:175], v[200:203], v[88:91], v[160:175]
  ds_read_b128 v[232:235], v8 offset:18432
  v_mfma_f32_32x32x16_bf16 v[176:191], v[204:207], v[88:91], v[176:191]
  ds_read_b128 v[236:239], v8 offset:19456
  v_add_f32 v240, v240, v252
  v_add_f32 v241, v241, v253
  s_waitcnt vmcnt(23)
  s_waitcnt lgkmcnt(4)
  v_mfma_f32_32x32x16_bf16 v[128:143], v[208:211], v[92:95], v[128:143]
  ds_read_b128 v[192:195], v8 offset:20480
  buffer_load_dwordx4 a[188:191], v4, s[4:7], s47 offen offset:3072
  s_add_u32 s46, s46, 4096
  s_add_u32 s47, s47, 4096
  v_mfma_f32_32x32x16_bf16 v[144:159], v[212:215], v[92:95], v[144:159]
  ds_read_b128 v[196:199], v8 offset:21504
  v_mov_b32 v14, v240
  v_mov_b32 v15, v241
  v_mfma_f32_32x32x16_bf16 v[160:175], v[216:219], v[92:95], v[160:175]
  ds_read_b128 v[200:203], v8 offset:22528
  v_mfma_f32_32x32x16_bf16 v[176:191], v[220:223], v[92:95], v[176:191]
  ds_read_b128 v[204:207], v8 offset:23552
  s_nop 1
  v_permlane32_swap_b32 v240, v14
  s_waitcnt vmcnt(23)
  s_waitcnt lgkmcnt(4)
  v_mfma_f32_32x32x16_bf16 v[128:143], v[224:227], v[96:99], v[128:143]
  ds_read_b128 v[208:211], v8 offset:24576
  buffer_load_dwordx4 a[192:195], v4, s[4:7], s46 offen offset:0
  v_mfma_f32_32x32x16_bf16 v[144:159], v[228:231], v[96:99], v[144:159]
  ds_read_b128 v[212:215], v8 offset:25600
  v_permlane32_swap_b32 v241, v15
  s_nop 1
  v_mfma_f32_32x32x16_bf16 v[160:175], v[232:235], v[96:99], v[160:175]
  ds_read_b128 v[216:219], v8 offset:26624
  v_mfma_f32_32x32x16_bf16 v[176:191], v[236:239], v[96:99], v[176:191]
  ds_read_b128 v[220:223], v8 offset:27648
  v_add_f32 v240, v240, v14
  v_add_f32 v241, v241, v15
  s_waitcnt vmcnt(23)
  s_waitcnt lgkmcnt(4)
  v_mfma_f32_32x32x16_bf16 v[128:143], v[192:195], v[100:103], v[128:143]
  ds_read_b128 v[224:227], v8 offset:28672
  buffer_load_dwordx4 a[196:199], v4, s[4:7], s47 offen offset:0
  v_mfma_f32_32x32x16_bf16 v[144:159], v[196:199], v[100:103], v[144:159]
  ds_read_b128 v[228:231], v8 offset:29696
  v_mul_f32 v10, 0xbb124925, v240
  v_mul_f32 v14, 0x3b124925, v241
  v_mfma_f32_32x32x16_bf16 v[160:175], v[200:203], v[100:103], v[160:175]
  ds_read_b128 v[232:235], v8 offset:30720
  v_mfma_f32_32x32x16_bf16 v[176:191], v[204:207], v[100:103], v[176:191]
  ds_read_b128 v[236:239], v8 offset:31744
  v_fma_f32 v14, -v10, v10, v14
  v_max_f32 v14, 0, v14
  s_waitcnt vmcnt(23)
  s_waitcnt lgkmcnt(4)
  v_mfma_f32_32x32x16_bf16 v[128:143], v[208:211], v[104:107], v[128:143]
  ds_read_b128 v[192:195], v8 offset:32768
  buffer_load_dwordx4 a[200:203], v4, s[4:7], s46 offen offset:1024
  v_mfma_f32_32x32x16_bf16 v[144:159], v[212:215], v[104:107], v[144:159]
  ds_read_b128 v[196:199], v8 offset:33792
  v_add_f32 v14, 0x3727c5ac, v14
  v_rsq_f32 v12, v14
  v_mfma_f32_32x32x16_bf16 v[160:175], v[216:219], v[104:107], v[160:175]
  ds_read_b128 v[200:203], v8 offset:34816
  v_mfma_f32_32x32x16_bf16 v[176:191], v[220:223], v[104:107], v[176:191]
  ds_read_b128 v[204:207], v8 offset:35840
  s_nop 0
  v_mul_f32 v14, v10, v12
  s_waitcnt vmcnt(23)
  s_waitcnt lgkmcnt(4)
  v_mfma_f32_32x32x16_bf16 v[128:143], v[224:227], v[108:111], v[128:143]
  ds_read_b128 v[208:211], v8 offset:36864
  buffer_load_dwordx4 a[204:207], v4, s[4:7], s47 offen offset:1024
  v_mfma_f32_32x32x16_bf16 v[144:159], v[228:231], v[108:111], v[144:159]
  ds_read_b128 v[212:215], v8 offset:37888
  v_mfma_f32_32x32x16_bf16 v[160:175], v[232:235], v[108:111], v[160:175]
  ds_read_b128 v[216:219], v8 offset:38912
  v_mfma_f32_32x32x16_bf16 v[176:191], v[236:239], v[108:111], v[176:191]
  ds_read_b128 v[220:223], v8 offset:39936
  s_waitcnt vmcnt(23)
  s_waitcnt lgkmcnt(4)
  v_mfma_f32_32x32x16_bf16 v[128:143], v[192:195], v[112:115], v[128:143]
  ds_read_b128 v[224:227], v8 offset:40960
  buffer_load_dwordx4 a[208:211], v4, s[4:7], s46 offen offset:2048
  v_mfma_f32_32x32x16_bf16 v[144:159], v[196:199], v[112:115], v[144:159]
  ds_read_b128 v[228:231], v8 offset:41984
  v_mfma_f32_32x32x16_bf16 v[160:175], v[200:203], v[112:115], v[160:175]
  ds_read_b128 v[232:235], v8 offset:43008
  v_mfma_f32_32x32x16_bf16 v[176:191], v[204:207], v[112:115], v[176:191]
  ds_read_b128 v[236:239], v8 offset:44032
  s_waitcnt vmcnt(23)
  s_waitcnt lgkmcnt(4)
  v_mfma_f32_32x32x16_bf16 v[128:143], v[208:211], v[116:119], v[128:143]
  ds_read_b128 v[192:195], v8 offset:45056
  buffer_load_dwordx4 a[212:215], v4, s[4:7], s47 offen offset:2048
  v_mfma_f32_32x32x16_bf16 v[144:159], v[212:215], v[116:119], v[144:159]
  ds_read_b128 v[196:199], v8 offset:46080
  v_mfma_f32_32x32x16_bf16 v[160:175], v[216:219], v[116:119], v[160:175]
  ds_read_b128 v[200:203], v8 offset:47104
  v_mfma_f32_32x32x16_bf16 v[176:191], v[220:223], v[116:119], v[176:191]
  ds_read_b128 v[204:207], v8 offset:48128
  s_waitcnt vmcnt(23)
  s_waitcnt lgkmcnt(4)
  v_mfma_f32_32x32x16_bf16 v[128:143], v[224:227], v[120:123], v[128:143]
  buffer_load_dwordx4 a[216:219], v4, s[4:7], s46 offen offset:3072
  v_mfma_f32_32x32x16_bf16 v[144:159], v[228:231], v[120:123], v[144:159]
  v_mfma_f32_32x32x16_bf16 v[160:175], v[232:235], v[120:123], v[160:175]
  v_mfma_f32_32x32x16_bf16 v[176:191], v[236:239], v[120:123], v[176:191]
  s_waitcnt vmcnt(23)
  s_waitcnt lgkmcnt(0)
  v_mfma_f32_32x32x16_bf16 v[128:143], v[192:195], v[124:127], v[128:143]
  buffer_load_dwordx4 a[220:223], v4, s[4:7], s47 offen offset:3072
  s_add_u32 s46, s46, 4096
  s_add_u32 s47, s47, 4096
  v_mfma_f32_32x32x16_bf16 v[144:159], v[196:199], v[124:127], v[144:159]
  v_mfma_f32_32x32x16_bf16 v[160:175], v[200:203], v[124:127], v[160:175]
  v_mfma_f32_32x32x16_bf16 v[176:191], v[204:207], v[124:127], v[176:191]
  s_barrier
  v_add_u32 v7, s49, v6
  s_mov_b32 s50, 0xbdd2d3e8
  s_mov_b32 s51, 0xbdd2d3e8
  v_mov_b32 v240, 0xc0135761
  v_mov_b32 v241, 0xc0135761
  s_mul_i32 s30, s26, 112
  s_lshl_b32 s31, s27, 3
  s_add_u32 s30, s30, s31
  s_lshl_b32 s30, s30, 10
  s_add_u32 s30, s30, s23
  s_waitcnt vmcnt(16)
  ds_read_b128 v[16:19], v7 offset:0
  ds_read_b128 v[32:35], v7 offset:512
  ds_read_b128 v[20:23], v7 offset:32
  ds_read_b128 v[36:39], v7 offset:544
  ds_read_b128 v[24:27], v7 offset:64
  ds_read_b128 v[40:43], v7 offset:576
  ds_read_b128 v[28:31], v7 offset:96
  ds_read_b128 v[44:47], v7 offset:608
  ds_read_b128 v[48:51], v7 offset:128
  ds_read_b128 v[64:67], v7 offset:640
  ds_read_b128 v[52:55], v7 offset:160
  ds_read_b128 v[68:71], v7 offset:672
  ds_read_b128 v[56:59], v7 offset:192
  ds_read_b128 v[72:75], v7 offset:704
  ds_read_b128 v[60:63], v7 offset:224
  ds_read_b128 v[76:79], v7 offset:736
  s_waitcnt lgkmcnt(8)
  v_pk_fma_f32 v[32:33], v[16:17], v[14:15], v[32:33] op_sel_hi:[1,0,1]
  v_pk_fma_f32 v[34:35], v[18:19], v[14:15], v[34:35] op_sel_hi:[1,0,1]
  v_pk_fma_f32 v[36:37], v[20:21], v[14:15], v[36:37] op_sel_hi:[1,0,1]
  v_pk_fma_f32 v[38:39], v[22:23], v[14:15], v[38:39] op_sel_hi:[1,0,1]
  v_pk_fma_f32 v[40:41], v[24:25], v[14:15], v[40:41] op_sel_hi:[1,0,1]
  v_pk_fma_f32 v[42:43], v[26:27], v[14:15], v[42:43] op_sel_hi:[1,0,1]
  v_pk_fma_f32 v[44:45], v[28:29], v[14:15], v[44:45] op_sel_hi:[1,0,1]
  v_pk_fma_f32 v[46:47], v[30:31], v[14:15], v[46:47] op_sel_hi:[1,0,1]
  v_pk_fma_f32 v[128:129], v[128:129], v[12:13], v[32:33] op_sel_hi:[1,0,1]
  v_pk_fma_f32 v[130:131], v[130:131], v[12:13], v[34:35] op_sel_hi:[1,0,1]
  v_pk_fma_f32 v[132:133], v[132:133], v[12:13], v[36:37] op_sel_hi:[1,0,1]
  v_pk_fma_f32 v[134:135], v[134:135], v[12:13], v[38:39] op_sel_hi:[1,0,1]
  v_pk_fma_f32 v[136:137], v[136:137], v[12:13], v[40:41] op_sel_hi:[1,0,1]
  v_pk_fma_f32 v[138:139], v[138:139], v[12:13], v[42:43] op_sel_hi:[1,0,1]
  v_pk_fma_f32 v[140:141], v[140:141], v[12:13], v[44:45] op_sel_hi:[1,0,1]
  v_pk_fma_f32 v[142:143], v[142:143], v[12:13], v[46:47] op_sel_hi:[1,0,1]
  ds_read_b128 v[16:19], v7 offset:256
  ds_read_b128 v[32:35], v7 offset:768
  ds_read_b128 v[20:23], v7 offset:288
  ds_read_b128 v[36:39], v7 offset:800
  ds_read_b128 v[24:27], v7 offset:320
  ds_read_b128 v[40:43], v7 offset:832
  ds_read_b128 v[28:31], v7 offset:352
  ds_read_b128 v[44:47], v7 offset:864
  v_pk_mul_f32 v[224:225], v[128:129], v[128:129]
  v_pk_mul_f32 v[226:227], v[130:131], v[130:131]
  v_pk_mul_f32 v[228:229], v[132:133], v[132:133]
  v_pk_mul_f32 v[230:231], v[134:135], v[134:135]
  v_pk_mul_f32 v[232:233], v[136:137], v[136:137]
  v_pk_mul_f32 v[234:235], v[138:139], v[138:139]
  v_pk_mul_f32 v[236:237], v[140:141], v[140:141]
  v_pk_mul_f32 v[238:239], v[142:143], v[142:143]
  v_pk_fma_f32 v[224:225], v[224:225], s[50:51], v[240:241]
  v_pk_fma_f32 v[226:227], v[226:227], s[50:51], v[240:241]
  v_pk_fma_f32 v[228:229], v[228:229], s[50:51], v[240:241]
  v_pk_fma_f32 v[230:231], v[230:231], s[50:51], v[240:241]
  v_pk_fma_f32 v[232:233], v[232:233], s[50:51], v[240:241]
  v_pk_fma_f32 v[234:235], v[234:235], s[50:51], v[240:241]
  v_pk_fma_f32 v[236:237], v[236:237], s[50:51], v[240:241]
  v_pk_fma_f32 v[238:239], v[238:239], s[50:51], v[240:241]
  v_pk_mul_f32 v[224:225], v[224:225], v[128:129]
  v_pk_mul_f32 v[226:227], v[226:227], v[130:131]
  v_pk_mul_f32 v[228:229], v[228:229], v[132:133]
  v_pk_mul_f32 v[230:231], v[230:231], v[134:135]
  v_pk_mul_f32 v[232:233], v[232:233], v[136:137]
  v_pk_mul_f32 v[234:235], v[234:235], v[138:139]
  v_pk_mul_f32 v[236:237], v[236:237], v[140:141]
  v_pk_mul_f32 v[238:239], v[238:239], v[142:143]
  v_exp_f32 v224, v224
  v_exp_f32 v225, v225
  v_exp_f32 v226, v226
  v_exp_f32 v227, v227
  v_exp_f32 v228, v228
  v_exp_f32 v229, v229
  v_exp_f32 v230, v230
  v_exp_f32 v231, v231
  v_exp_f32 v232, v232
  v_exp_f32 v233, v233
  v_exp_f32 v234, v234
  v_exp_f32 v235, v235
  v_exp_f32 v236, v236
  v_exp_f32 v237, v237
  v_exp_f32 v238, v238
  v_exp_f32 v239, v239
  v_pk_add_f32 v[224:225], v[224:225], 1.0 op_sel_hi:[1,0]
  v_pk_add_f32 v[226:227], v[226:227], 1.0 op_sel_hi:[1,0]
  v_pk_add_f32 v[228:229], v[228:229], 1.0 op_sel_hi:[1,0]
  v_pk_add_f32 v[230:231], v[230:231], 1.0 op_sel_hi:[1,0]
  v_pk_add_f32 v[232:233], v[232:233], 1.0 op_sel_hi:[1,0]
  v_pk_add_f32 v[234:235], v[234:235], 1.0 op_sel_hi:[1,0]
  v_pk_add_f32 v[236:237], v[236:237], 1.0 op_sel_hi:[1,0]
  v_pk_add_f32 v[238:239], v[238:239], 1.0 op_sel_hi:[1,0]
  v_rcp_f32 v224, v224
  v_rcp_f32 v225, v225
  v_rcp_f32 v226, v226
  v_rcp_f32 v227, v227
  v_rcp_f32 v228, v228
  v_rcp_f32 v229, v229
  v_rcp_f32 v230, v230
  v_rcp_f32 v231, v231
  v_rcp_f32 v232, v232
  v_rcp_f32 v233, v233
  v_rcp_f32 v234, v234
  v_rcp_f32 v235, v235
  v_rcp_f32 v236, v236
  v_rcp_f32 v237, v237
  v_rcp_f32 v238, v238
  v_rcp_f32 v239, v239
  v_pk_mul_f32 v[128:129], v[128:129], v[224:225]
  v_pk_mul_f32 v[130:131], v[130:131], v[226:227]
  v_pk_mul_f32 v[132:133], v[132:133], v[228:229]
  v_pk_mul_f32 v[134:135], v[134:135], v[230:231]
  v_pk_mul_f32 v[136:137], v[136:137], v[232:233]
  v_pk_mul_f32 v[138:139], v[138:139], v[234:235]
  v_pk_mul_f32 v[140:141], v[140:141], v[236:237]
  v_pk_mul_f32 v[142:143], v[142:143], v[238:239]
  v_cvt_pk_bf16_f32 v128, v128, v129
  v_cvt_pk_bf16_f32 v129, v130, v131
  v_cvt_pk_bf16_f32 v130, v132, v133
  v_cvt_pk_bf16_f32 v131, v134, v135
  v_cvt_pk_bf16_f32 v132, v136, v137
  v_cvt_pk_bf16_f32 v133, v138, v139
  v_cvt_pk_bf16_f32 v134, v140, v141
  v_cvt_pk_bf16_f32 v135, v142, v143
  buffer_store_dwordx4 v[128:131], v4, s[4:7], s30 offen offset:0
  buffer_store_dwordx4 v[132:135], v4, s[4:7], s30 offen offset:1024
  s_waitcnt lgkmcnt(8)
  v_pk_fma_f32 v[64:65], v[48:49], v[14:15], v[64:65] op_sel_hi:[1,0,1]
  v_pk_fma_f32 v[66:67], v[50:51], v[14:15], v[66:67] op_sel_hi:[1,0,1]
  v_pk_fma_f32 v[68:69], v[52:53], v[14:15], v[68:69] op_sel_hi:[1,0,1]
  v_pk_fma_f32 v[70:71], v[54:55], v[14:15], v[70:71] op_sel_hi:[1,0,1]
  v_pk_fma_f32 v[72:73], v[56:57], v[14:15], v[72:73] op_sel_hi:[1,0,1]
  v_pk_fma_f32 v[74:75], v[58:59], v[14:15], v[74:75] op_sel_hi:[1,0,1]
  v_pk_fma_f32 v[76:77], v[60:61], v[14:15], v[76:77] op_sel_hi:[1,0,1]
  v_pk_fma_f32 v[78:79], v[62:63], v[14:15], v[78:79] op_sel_hi:[1,0,1]
  v_pk_fma_f32 v[144:145], v[144:145], v[12:13], v[64:65] op_sel_hi:[1,0,1]
  v_pk_fma_f32 v[146:147], v[146:147], v[12:13], v[66:67] op_sel_hi:[1,0,1]
  v_pk_fma_f32 v[148:149], v[148:149], v[12:13], v[68:69] op_sel_hi:[1,0,1]
  v_pk_fma_f32 v[150:151], v[150:151], v[12:13], v[70:71] op_sel_hi:[1,0,1]
  v_pk_fma_f32 v[152:153], v[152:153], v[12:13], v[72:73] op_sel_hi:[1,0,1]
  v_pk_fma_f32 v[154:155], v[154:155], v[12:13], v[74:75] op_sel_hi:[1,0,1]
  v_pk_fma_f32 v[156:157], v[156:157], v[12:13], v[76:77] op_sel_hi:[1,0,1]
  v_pk_fma_f32 v[158:159], v[158:159], v[12:13], v[78:79] op_sel_hi:[1,0,1]
  ds_read_b128 v[48:51], v7 offset:384
  ds_read_b128 v[64:67], v7 offset:896
  ds_read_b128 v[52:55], v7 offset:416
  ds_read_b128 v[68:71], v7 offset:928
  ds_read_b128 v[56:59], v7 offset:448
  ds_read_b128 v[72:75], v7 offset:960
  ds_read_b128 v[60:63], v7 offset:480
  ds_read_b128 v[76:79], v7 offset:992
  v_pk_mul_f32 v[224:225], v[144:145], v[144:145]
  v_pk_mul_f32 v[226:227], v[146:147], v[146:147]
  v_pk_mul_f32 v[228:229], v[148:149], v[148:149]
  v_pk_mul_f32 v[230:231], v[150:151], v[150:151]
  v_pk_mul_f32 v[232:233], v[152:153], v[152:153]
  v_pk_mul_f32 v[234:235], v[154:155], v[154:155]
  v_pk_mul_f32 v[236:237], v[156:157], v[156:157]
  v_pk_mul_f32 v[238:239], v[158:159], v[158:159]
  v_pk_fma_f32 v[224:225], v[224:225], s[50:51], v[240:241]
  v_pk_fma_f32 v[226:227], v[226:227], s[50:51], v[240:241]
  v_pk_fma_f32 v[228:229], v[228:229], s[50:51], v[240:241]
  v_pk_fma_f32 v[230:231], v[230:231], s[50:51], v[240:241]
  v_pk_fma_f32 v[232:233], v[232:233], s[50:51], v[240:241]
  v_pk_fma_f32 v[234:235], v[234:235], s[50:51], v[240:241]
  v_pk_fma_f32 v[236:237], v[236:237], s[50:51], v[240:241]
  v_pk_fma_f32 v[238:239], v[238:239], s[50:51], v[240:241]
  v_pk_mul_f32 v[224:225], v[224:225], v[144:145]
  v_pk_mul_f32 v[226:227], v[226:227], v[146:147]
  v_pk_mul_f32 v[228:229], v[228:229], v[148:149]
  v_pk_mul_f32 v[230:231], v[230:231], v[150:151]
  v_pk_mul_f32 v[232:233], v[232:233], v[152:153]
  v_pk_mul_f32 v[234:235], v[234:235], v[154:155]
  v_pk_mul_f32 v[236:237], v[236:237], v[156:157]
  v_pk_mul_f32 v[238:239], v[238:239], v[158:159]
  v_exp_f32 v224, v224
  v_exp_f32 v225, v225
  v_exp_f32 v226, v226
  v_exp_f32 v227, v227
  v_exp_f32 v228, v228
  v_exp_f32 v229, v229
  v_exp_f32 v230, v230
  v_exp_f32 v231, v231
  v_exp_f32 v232, v232
  v_exp_f32 v233, v233
  v_exp_f32 v234, v234
  v_exp_f32 v235, v235
  v_exp_f32 v236, v236
  v_exp_f32 v237, v237
  v_exp_f32 v238, v238
  v_exp_f32 v239, v239
  v_pk_add_f32 v[224:225], v[224:225], 1.0 op_sel_hi:[1,0]
  v_pk_add_f32 v[226:227], v[226:227], 1.0 op_sel_hi:[1,0]
  v_pk_add_f32 v[228:229], v[228:229], 1.0 op_sel_hi:[1,0]
  v_pk_add_f32 v[230:231], v[230:231], 1.0 op_sel_hi:[1,0]
  v_pk_add_f32 v[232:233], v[232:233], 1.0 op_sel_hi:[1,0]
  v_pk_add_f32 v[234:235], v[234:235], 1.0 op_sel_hi:[1,0]
  v_pk_add_f32 v[236:237], v[236:237], 1.0 op_sel_hi:[1,0]
  v_pk_add_f32 v[238:239], v[238:239], 1.0 op_sel_hi:[1,0]
  v_rcp_f32 v224, v224
  v_rcp_f32 v225, v225
  v_rcp_f32 v226, v226
  v_rcp_f32 v227, v227
  v_rcp_f32 v228, v228
  v_rcp_f32 v229, v229
  v_rcp_f32 v230, v230
  v_rcp_f32 v231, v231
  v_rcp_f32 v232, v232
  v_rcp_f32 v233, v233
  v_rcp_f32 v234, v234
  v_rcp_f32 v235, v235
  v_rcp_f32 v236, v236
  v_rcp_f32 v237, v237
  v_rcp_f32 v238, v238
  v_rcp_f32 v239, v239
  v_pk_mul_f32 v[144:145], v[144:145], v[224:225]
  v_pk_mul_f32 v[146:147], v[146:147], v[226:227]
  v_pk_mul_f32 v[148:149], v[148:149], v[228:229]
  v_pk_mul_f32 v[150:151], v[150:151], v[230:231]
  v_pk_mul_f32 v[152:153], v[152:153], v[232:233]
  v_pk_mul_f32 v[154:155], v[154:155], v[234:235]
  v_pk_mul_f32 v[156:157], v[156:157], v[236:237]
  v_pk_mul_f32 v[158:159], v[158:159], v[238:239]
  v_cvt_pk_bf16_f32 v144, v144, v145
  v_cvt_pk_bf16_f32 v145, v146, v147
  v_cvt_pk_bf16_f32 v146, v148, v149
  v_cvt_pk_bf16_f32 v147, v150, v151
  v_cvt_pk_bf16_f32 v148, v152, v153
  v_cvt_pk_bf16_f32 v149, v154, v155
  v_cvt_pk_bf16_f32 v150, v156, v157
  v_cvt_pk_bf16_f32 v151, v158, v159
  buffer_store_dwordx4 v[144:147], v4, s[4:7], s30 offen offset:2048
  buffer_store_dwordx4 v[148:151], v4, s[4:7], s30 offen offset:3072
  s_waitcnt lgkmcnt(8)
  v_pk_fma_f32 v[32:33], v[16:17], v[14:15], v[32:33] op_sel_hi:[1,0,1]
  v_pk_fma_f32 v[34:35], v[18:19], v[14:15], v[34:35] op_sel_hi:[1,0,1]
  v_pk_fma_f32 v[36:37], v[20:21], v[14:15], v[36:37] op_sel_hi:[1,0,1]
  v_pk_fma_f32 v[38:39], v[22:23], v[14:15], v[38:39] op_sel_hi:[1,0,1]
  v_pk_fma_f32 v[40:41], v[24:25], v[14:15], v[40:41] op_sel_hi:[1,0,1]
  v_pk_fma_f32 v[42:43], v[26:27], v[14:15], v[42:43] op_sel_hi:[1,0,1]
  v_pk_fma_f32 v[44:45], v[28:29], v[14:15], v[44:45] op_sel_hi:[1,0,1]
  v_pk_fma_f32 v[46:47], v[30:31], v[14:15], v[46:47] op_sel_hi:[1,0,1]
  v_pk_fma_f32 v[160:161], v[160:161], v[12:13], v[32:33] op_sel_hi:[1,0,1]
  v_pk_fma_f32 v[162:163], v[162:163], v[12:13], v[34:35] op_sel_hi:[1,0,1]
  v_pk_fma_f32 v[164:165], v[164:165], v[12:13], v[36:37] op_sel_hi:[1,0,1]
  v_pk_fma_f32 v[166:167], v[166:167], v[12:13], v[38:39] op_sel_hi:[1,0,1]
  v_pk_fma_f32 v[168:169], v[168:169], v[12:13], v[40:41] op_sel_hi:[1,0,1]
  v_pk_fma_f32 v[170:171], v[170:171], v[12:13], v[42:43] op_sel_hi:[1,0,1]
  v_pk_fma_f32 v[172:173], v[172:173], v[12:13], v[44:45] op_sel_hi:[1,0,1]
  v_pk_fma_f32 v[174:175], v[174:175], v[12:13], v[46:47] op_sel_hi:[1,0,1]
  v_pk_mul_f32 v[224:225], v[160:161], v[160:161]
  v_pk_mul_f32 v[226:227], v[162:163], v[162:163]
  v_pk_mul_f32 v[228:229], v[164:165], v[164:165]
  v_pk_mul_f32 v[230:231], v[166:167], v[166:167]
  v_pk_mul_f32 v[232:233], v[168:169], v[168:169]
  v_pk_mul_f32 v[234:235], v[170:171], v[170:171]
  v_pk_mul_f32 v[236:237], v[172:173], v[172:173]
  v_pk_mul_f32 v[238:239], v[174:175], v[174:175]
  v_pk_fma_f32 v[224:225], v[224:225], s[50:51], v[240:241]
  v_pk_fma_f32 v[226:227], v[226:227], s[50:51], v[240:241]
  v_pk_fma_f32 v[228:229], v[228:229], s[50:51], v[240:241]
  v_pk_fma_f32 v[230:231], v[230:231], s[50:51], v[240:241]
  v_pk_fma_f32 v[232:233], v[232:233], s[50:51], v[240:241]
  v_pk_fma_f32 v[234:235], v[234:235], s[50:51], v[240:241]
  v_pk_fma_f32 v[236:237], v[236:237], s[50:51], v[240:241]
  v_pk_fma_f32 v[238:239], v[238:239], s[50:51], v[240:241]
  v_pk_mul_f32 v[224:225], v[224:225], v[160:161]
  v_pk_mul_f32 v[226:227], v[226:227], v[162:163]
  v_pk_mul_f32 v[228:229], v[228:229], v[164:165]
  v_pk_mul_f32 v[230:231], v[230:231], v[166:167]
  v_pk_mul_f32 v[232:233], v[232:233], v[168:169]
  v_pk_mul_f32 v[234:235], v[234:235], v[170:171]
  v_pk_mul_f32 v[236:237], v[236:237], v[172:173]
  v_pk_mul_f32 v[238:239], v[238:239], v[174:175]
  v_exp_f32 v224, v224
  v_exp_f32 v225, v225
  v_exp_f32 v226, v226
  v_exp_f32 v227, v227
  v_exp_f32 v228, v228
  v_exp_f32 v229, v229
  v_exp_f32 v230, v230
  v_exp_f32 v231, v231
  v_exp_f32 v232, v232
  v_exp_f32 v233, v233
  v_exp_f32 v234, v234
  v_exp_f32 v235, v235
  v_exp_f32 v236, v236
  v_exp_f32 v237, v237
  v_exp_f32 v238, v238
  v_exp_f32 v239, v239
  v_pk_add_f32 v[224:225], v[224:225], 1.0 op_sel_hi:[1,0]
  v_pk_add_f32 v[226:227], v[226:227], 1.0 op_sel_hi:[1,0]
  v_pk_add_f32 v[228:229], v[228:229], 1.0 op_sel_hi:[1,0]
  v_pk_add_f32 v[230:231], v[230:231], 1.0 op_sel_hi:[1,0]
  v_pk_add_f32 v[232:233], v[232:233], 1.0 op_sel_hi:[1,0]
  v_pk_add_f32 v[234:235], v[234:235], 1.0 op_sel_hi:[1,0]
  v_pk_add_f32 v[236:237], v[236:237], 1.0 op_sel_hi:[1,0]
  v_pk_add_f32 v[238:239], v[238:239], 1.0 op_sel_hi:[1,0]
  v_rcp_f32 v224, v224
  v_rcp_f32 v225, v225
  v_rcp_f32 v226, v226
  v_rcp_f32 v227, v227
  v_rcp_f32 v228, v228
  v_rcp_f32 v229, v229
  v_rcp_f32 v230, v230
  v_rcp_f32 v231, v231
  v_rcp_f32 v232, v232
  v_rcp_f32 v233, v233
  v_rcp_f32 v234, v234
  v_rcp_f32 v235, v235
  v_rcp_f32 v236, v236
  v_rcp_f32 v237, v237
  v_rcp_f32 v238, v238
  v_rcp_f32 v239, v239
  v_pk_mul_f32 v[160:161], v[160:161], v[224:225]
  v_pk_mul_f32 v[162:163], v[162:163], v[226:227]
  v_pk_mul_f32 v[164:165], v[164:165], v[228:229]
  v_pk_mul_f32 v[166:167], v[166:167], v[230:231]
  v_pk_mul_f32 v[168:169], v[168:169], v[232:233]
  v_pk_mul_f32 v[170:171], v[170:171], v[234:235]
  v_pk_mul_f32 v[172:173], v[172:173], v[236:237]
  v_pk_mul_f32 v[174:175], v[174:175], v[238:239]
  v_cvt_pk_bf16_f32 v160, v160, v161
  v_cvt_pk_bf16_f32 v161, v162, v163
  v_cvt_pk_bf16_f32 v162, v164, v165
  v_cvt_pk_bf16_f32 v163, v166, v167
  v_cvt_pk_bf16_f32 v164, v168, v169
  v_cvt_pk_bf16_f32 v165, v170, v171
  v_cvt_pk_bf16_f32 v166, v172, v173
  v_cvt_pk_bf16_f32 v167, v174, v175
  s_add_u32 s30, s30, 4096
  buffer_store_dwordx4 v[160:163], v4, s[4:7], s30 offen offset:0
  buffer_store_dwordx4 v[164:167], v4, s[4:7], s30 offen offset:1024
  s_waitcnt lgkmcnt(0)
  v_pk_fma_f32 v[64:65], v[48:49], v[14:15], v[64:65] op_sel_hi:[1,0,1]
  v_pk_fma_f32 v[66:67], v[50:51], v[14:15], v[66:67] op_sel_hi:[1,0,1]
  v_pk_fma_f32 v[68:69], v[52:53], v[14:15], v[68:69] op_sel_hi:[1,0,1]
  v_pk_fma_f32 v[70:71], v[54:55], v[14:15], v[70:71] op_sel_hi:[1,0,1]
  v_pk_fma_f32 v[72:73], v[56:57], v[14:15], v[72:73] op_sel_hi:[1,0,1]
  v_pk_fma_f32 v[74:75], v[58:59], v[14:15], v[74:75] op_sel_hi:[1,0,1]
  v_pk_fma_f32 v[76:77], v[60:61], v[14:15], v[76:77] op_sel_hi:[1,0,1]
  v_pk_fma_f32 v[78:79], v[62:63], v[14:15], v[78:79] op_sel_hi:[1,0,1]
  v_pk_fma_f32 v[176:177], v[176:177], v[12:13], v[64:65] op_sel_hi:[1,0,1]
  v_pk_fma_f32 v[178:179], v[178:179], v[12:13], v[66:67] op_sel_hi:[1,0,1]
  v_pk_fma_f32 v[180:181], v[180:181], v[12:13], v[68:69] op_sel_hi:[1,0,1]
  v_pk_fma_f32 v[182:183], v[182:183], v[12:13], v[70:71] op_sel_hi:[1,0,1]
  v_pk_fma_f32 v[184:185], v[184:185], v[12:13], v[72:73] op_sel_hi:[1,0,1]
  v_pk_fma_f32 v[186:187], v[186:187], v[12:13], v[74:75] op_sel_hi:[1,0,1]
  v_pk_fma_f32 v[188:189], v[188:189], v[12:13], v[76:77] op_sel_hi:[1,0,1]
  v_pk_fma_f32 v[190:191], v[190:191], v[12:13], v[78:79] op_sel_hi:[1,0,1]
  v_pk_mul_f32 v[224:225], v[176:177], v[176:177]
  v_pk_mul_f32 v[226:227], v[178:179], v[178:179]
  v_pk_mul_f32 v[228:229], v[180:181], v[180:181]
  v_pk_mul_f32 v[230:231], v[182:183], v[182:183]
  v_pk_mul_f32 v[232:233], v[184:185], v[184:185]
  v_pk_mul_f32 v[234:235], v[186:187], v[186:187]
  v_pk_mul_f32 v[236:237], v[188:189], v[188:189]
  v_pk_mul_f32 v[238:239], v[190:191], v[190:191]
  v_pk_fma_f32 v[224:225], v[224:225], s[50:51], v[240:241]
  v_pk_fma_f32 v[226:227], v[226:227], s[50:51], v[240:241]
  v_pk_fma_f32 v[228:229], v[228:229], s[50:51], v[240:241]
  v_pk_fma_f32 v[230:231], v[230:231], s[50:51], v[240:241]
  v_pk_fma_f32 v[232:233], v[232:233], s[50:51], v[240:241]
  v_pk_fma_f32 v[234:235], v[234:235], s[50:51], v[240:241]
  v_pk_fma_f32 v[236:237], v[236:237], s[50:51], v[240:241]
  v_pk_fma_f32 v[238:239], v[238:239], s[50:51], v[240:241]
  v_pk_mul_f32 v[224:225], v[224:225], v[176:177]
  v_pk_mul_f32 v[226:227], v[226:227], v[178:179]
  v_pk_mul_f32 v[228:229], v[228:229], v[180:181]
  v_pk_mul_f32 v[230:231], v[230:231], v[182:183]
  v_pk_mul_f32 v[232:233], v[232:233], v[184:185]
  v_pk_mul_f32 v[234:235], v[234:235], v[186:187]
  v_pk_mul_f32 v[236:237], v[236:237], v[188:189]
  v_pk_mul_f32 v[238:239], v[238:239], v[190:191]
  v_exp_f32 v224, v224
  v_exp_f32 v225, v225
  v_exp_f32 v226, v226
  v_exp_f32 v227, v227
  v_exp_f32 v228, v228
  v_exp_f32 v229, v229
  v_exp_f32 v230, v230
  v_exp_f32 v231, v231
  v_exp_f32 v232, v232
  v_exp_f32 v233, v233
  v_exp_f32 v234, v234
  v_exp_f32 v235, v235
  v_exp_f32 v236, v236
  v_exp_f32 v237, v237
  v_exp_f32 v238, v238
  v_exp_f32 v239, v239
  v_pk_add_f32 v[224:225], v[224:225], 1.0 op_sel_hi:[1,0]
  v_pk_add_f32 v[226:227], v[226:227], 1.0 op_sel_hi:[1,0]
  v_pk_add_f32 v[228:229], v[228:229], 1.0 op_sel_hi:[1,0]
  v_pk_add_f32 v[230:231], v[230:231], 1.0 op_sel_hi:[1,0]
  v_pk_add_f32 v[232:233], v[232:233], 1.0 op_sel_hi:[1,0]
  v_pk_add_f32 v[234:235], v[234:235], 1.0 op_sel_hi:[1,0]
  v_pk_add_f32 v[236:237], v[236:237], 1.0 op_sel_hi:[1,0]
  v_pk_add_f32 v[238:239], v[238:239], 1.0 op_sel_hi:[1,0]
  v_rcp_f32 v224, v224
  v_rcp_f32 v225, v225
  v_rcp_f32 v226, v226
  v_rcp_f32 v227, v227
  v_rcp_f32 v228, v228
  v_rcp_f32 v229, v229
  v_rcp_f32 v230, v230
  v_rcp_f32 v231, v231
  v_rcp_f32 v232, v232
  v_rcp_f32 v233, v233
  v_rcp_f32 v234, v234
  v_rcp_f32 v235, v235
  v_rcp_f32 v236, v236
  v_rcp_f32 v237, v237
  v_rcp_f32 v238, v238
  v_rcp_f32 v239, v239
  v_pk_mul_f32 v[176:177], v[176:177], v[224:225]
  v_pk_mul_f32 v[178:179], v[178:179], v[226:227]
  v_pk_mul_f32 v[180:181], v[180:181], v[228:229]
  v_pk_mul_f32 v[182:183], v[182:183], v[230:231]
  v_pk_mul_f32 v[184:185], v[184:185], v[232:233]
  v_pk_mul_f32 v[186:187], v[186:187], v[234:235]
  v_pk_mul_f32 v[188:189], v[188:189], v[236:237]
  v_pk_mul_f32 v[190:191], v[190:191], v[238:239]
  v_cvt_pk_bf16_f32 v176, v176, v177
  v_cvt_pk_bf16_f32 v177, v178, v179
  v_cvt_pk_bf16_f32 v178, v180, v181
  v_cvt_pk_bf16_f32 v179, v182, v183
  v_cvt_pk_bf16_f32 v180, v184, v185
  v_cvt_pk_bf16_f32 v181, v186, v187
  v_cvt_pk_bf16_f32 v182, v188, v189
  v_cvt_pk_bf16_f32 v183, v190, v191
  buffer_store_dwordx4 v[176:179], v4, s[4:7], s30 offen offset:2048
  buffer_store_dwordx4 v[180:183], v4, s[4:7], s30 offen offset:3072
ffn1_skip:
  s_waitcnt vmcnt(0) lgkmcnt(0)
  s_barrier
  s_add_u32 s15, s15, 1
  s_cmp_lg_u32 s3, 0
  s_cbranch_scc1 lb_end_28
  v_lshlrev_b32 v5, 2, v2
  s_lshl_b32 s40, s12, 7
  s_mov_b32 s42, 0
  s_cmp_lg_u32 s15, 1
  s_cbranch_scc1 lb_known_32
  s_add_u32 s41, s40, 0x4e0000
lb_px_33:
  s_add_u32 s42, s42, 1
  s_cmp_gt_u32 s42, 0x40000
  s_cbranch_scc1 lb_known_32
  buffer_load_dword v6, v5, s[4:7], s41 offen sc0 sc1
  s_waitcnt vmcnt(0)
  v_and_b32 v7, -16, v6
  v_cmp_ne_u32 vcc, s67, v7
  s_cbranch_vccnz lb_px_33
  v_readfirstlane_b32 s43, v6
  s_nop 1
  v_cmp_ne_u32 vcc, s43, v6
  s_mov_b32 s16, 0
  s_cbranch_vccnz lb_known_32
  s_mov_b32 s16, 1
lb_known_32:
  s_add_u32 s41, s40, 0x4e1000
  s_lshl_b32 s43, s13, 2
  s_add_u32 s43, s43, s41
  s_add_u32 s40, s67, s15
  v_mov_b32 v6, s40
  v_mov_b32 v7, 0
  s_mov_b32 s42, 0
  s_cmp_eq_u32 s16, 0
  s_cbranch_scc1 lb_slow_29
  s_mov_b64 exec, 1
  buffer_store_dword v6, v7, s[4:7], s43 offen
  s_mov_b64 exec, -1
lb_poll_30:
  s_add_u32 s42, s42, 1
  s_cmp_gt_u32 s42, 0x40000
  s_cbranch_scc1 lb_end_28
  buffer_load_dword v6, v5, s[4:7], s41 offen sc1
  s_waitcnt vmcnt(0)
  v_subrev_u32 v6, s40, v6
  v_cmp_le_u32 vcc, 8, v6
  s_cbranch_vccnz lb_poll_30
  s_branch lb_end_28
lb_slow_29:
  buffer_wbl2 sc1
  s_waitcnt vmcnt(0)
  s_mov_b64 exec, 1
  buffer_store_dword v6, v7, s[4:7], s43 offen sc0 sc1
  s_mov_b64 exec, -1
lb_poll2_31:
  s_add_u32 s42, s42, 1
  s_cmp_gt_u32 s42, 0x40000
  s_cbranch_scc1 lb_done_34
  buffer_load_dword v6, v5, s[4:7], s41 offen sc0 sc1
  s_waitcnt vmcnt(0)
  v_subrev_u32 v6, s40, v6
  v_cmp_le_u32 vcc, 8, v6
  s_cbranch_vccnz lb_poll2_31
lb_done_34:
  buffer_inv sc1
  s_waitcnt vmcnt(0)
lb_end_28:
  s_barrier
  s_cmp_ge_u32 s13, 28
  s_cbranch_scc1 ffn2_skip
  s_mul_i32 s30, s28, 229376
  s_mul_i32 s31, s3, 28672
  s_add_u32 s30, s30, s31
  s_add_u32 s30, s30, s23
  s_add_u32 s31, s30, 114688
  buffer_load_dwordx4 v[96:99], v4, s[4:7], s30 offen offset:0 sc1
  buffer_load_dwordx4 v[100:103], v4, s[4:7], s31 offen offset:0 sc1
  buffer_load_dwordx4 v[104:107], v4, s[4:7], s30 offen offset:1024 sc1
  buffer_load_dwordx4 v[108:111], v4, s[4:7], s31 offen offset:1024 sc1
  buffer_load_dwordx4 v[112:115], v4, s[4:7], s30 offen offset:2048 sc1
  buffer_load_dwordx4 v[116:119], v4, s[4:7], s31 offen offset:2048 sc1
  buffer_load_dwordx4 v[120:123], v4, s[4:7], s30 offen offset:3072 sc1
  buffer_load_dwordx4 v[124:127], v4, s[4:7], s31 offen offset:3072 sc1
  s_add_u32 s30, s30, 4096
  s_add_u32 s31, s31, 4096
  buffer_load_dwordx4 v[128:131], v4, s[4:7], s30 offen offset:0 sc1
  buffer_load_dwordx4 v[132:135], v4, s[4:7], s31 offen offset:0 sc1
  s_lshr_b32 s44, s13, 1
  s_mul_i32 s44, s44, 86016
  s_mul_i32 s45, s3, 3072
  s_add_u32 s44, s44, s45
  s_add_u32 s44, s44, 0x0
  s_waitcnt vmcnt(8)
  v_mfma_f32_32x32x16_bf16 v[32:47], a[0:3], v[96:99], 0
  buffer_load_dwordx4 v[136:139], v4, s[4:7], s30 offen offset:1024 sc1
  v_mfma_f32_32x32x16_bf16 v[48:63], a[4:7], v[96:99], 0
  buffer_load_dwordx4 v[140:143], v4, s[4:7], s31 offen offset:1024 sc1
  v_mfma_f32_32x32x16_bf16 v[64:79], a[0:3], v[100:103], 0
  v_mfma_f32_32x32x16_bf16 v[80:95], a[4:7], v[100:103], 0
  s_waitcnt vmcnt(8)
  v_mfma_f32_32x32x16_bf16 v[32:47], a[8:11], v[104:107], v[32:47]
  buffer_load_dwordx4 v[144:147], v4, s[4:7], s30 offen offset:2048 sc1
  v_mfma_f32_32x32x16_bf16 v[48:63], a[12:15], v[104:107], v[48:63]
  buffer_load_dwordx4 v[148:151], v4, s[4:7], s31 offen offset:2048 sc1
  v_mfma_f32_32x32x16_bf16 v[64:79], a[8:11], v[108:111], v[64:79]
  v_mfma_f32_32x32x16_bf16 v[80:95], a[12:15], v[108:111], v[80:95]
  s_waitcnt vmcnt(8)
  v_mfma_f32_32x32x16_bf16 v[32:47], a[16:19], v[112:115], v[32:47]
  buffer_load_dwordx4 v[152:155], v4, s[4:7], s30 offen offset:3072 sc1
  v_mfma_f32_32x32x16_bf16 v[48:63], a[20:23], v[112:115], v[48:63]
  buffer_load_dwordx4 v[156:159], v4, s[4:7], s31 offen offset:3072 sc1
  s_add_u32 s30, s30, 4096
  s_add_u32 s31, s31, 4096
  v_mfma_f32_32x32x16_bf16 v[64:79], a[16:19], v[116:119], v[64:79]
  v_mfma_f32_32x32x16_bf16 v[80:95], a[20:23], v[116:119], v[80:95]
  s_waitcnt vmcnt(8)
  v_mfma_f32_32x32x16_bf16 v[32:47], a[24:27], v[120:123], v[32:47]
  buffer_load_dwordx4 v[160:163], v4, s[4:7], s30 offen offset:0 sc1
  v_mfma_f32_32x32x16_bf16 v[48:63], a[28:31], v[120:123], v[48:63]
  buffer_load_dwordx4 v[164:167], v4, s[4:7], s31 offen offset:0 sc1
  v_mfma_f32_32x32x16_bf16 v[64:79], a[24:27], v[124:127], v[64:79]
  v_mfma_f32_32x32x16_bf16 v[80:95], a[28:31], v[124:127], v[80:95]
  s_waitcnt vmcnt(8)
  v_mfma_f32_32x32x16_bf16 v[32:47], a[32:35], v[128:131], v[32:47]
  buffer_load_dwordx4 v[168:171], v4, s[4:7], s30 offen offset:1024 sc1
  v_mfma_f32_32x32x16_bf16 v[48:63], a[36:39], v[128:131], v[48:63]
  buffer_load_dwordx4 v[172:175], v4, s[4:7], s31 offen offset:1024 sc1
  v_mfma_f32_32x32x16_bf16 v[64:79], a[32:35], v[132:135], v[64:79]
  v_mfma_f32_32x32x16_bf16 v[80:95], a[36:39], v[132:135], v[80:95]
  s_waitcnt vmcnt(8)
  v_mfma_f32_32x32x16_bf16 v[32:47], a[40:43], v[136:139], v[32:47]
  buffer_load_dwordx4 v[176:179], v4, s[4:7], s30 offen offset:2048 sc1
  v_mfma_f32_32x32x16_bf16 v[48:63], a[44:47], v[136:139], v[48:63]
  buffer_load_dwordx4 v[180:183], v4, s[4:7], s31 offen offset:2048 sc1
  v_mfma_f32_32x32x16_bf16 v[64:79], a[40:43], v[140:143], v[64:79]
  v_mfma_f32_32x32x16_bf16 v[80:95], a[44:47], v[140:143], v[80:95]
  s_waitcnt vmcnt(8)
  v_mfma_f32_32x32x16_bf16 v[32:47], a[48:51], v[144:147], v[32:47]
  buffer_load_dwordx4 v[184:187], v4, s[4:7], s30 offen offset:3072 sc1
  v_mfma_f32_32x32x16_bf16 v[48:63], a[52:55], v[144:147], v[48:63]
  buffer_load_dwordx4 v[188:191], v4, s[4:7], s31 offen offset:3072 sc1
  s_add_u32 s30, s30, 4096
  s_add_u32 s31, s31, 4096
  v_mfma_f32_32x32x16_bf16 v[64:79], a[48:51], v[148:151], v[64:79]
  v_mfma_f32_32x32x16_bf16 v[80:95], a[52:55], v[148:151], v[80:95]
  s_waitcnt vmcnt(8)
  v_mfma_f32_32x32x16_bf16 v[32:47], a[56:59], v[152:155], v[32:47]
  buffer_load_dwordx4 v[96:99], v4, s[4:7], s30 offen offset:0 sc1
  v_mfma_f32_32x32x16_bf16 v[48:63], a[60:63], v[152:155], v[48:63]
  buffer_load_dwordx4 v[100:103], v4, s[4:7], s31 offen offset:0 sc1
  v_mfma_f32_32x32x16_bf16 v[64:79], a[56:59], v[156:159], v[64:79]
  v_mfma_f32_32x32x16_bf16 v[80:95], a[60:63], v[156:159], v[80:95]
  s_waitcnt vmcnt(8)
  v_mfma_f32_32x32x16_bf16 v[32:47], a[64:67], v[160:163], v[32:47]
  buffer_load_dwordx4 v[104:107], v4, s[4:7], s30 offen offset:1024 sc1
  v_mfma_f32_32x32x16_bf16 v[48:63], a[68:71], v[160:163], v[48:63]
  buffer_load_dwordx4 v[108:111], v4, s[4:7], s31 offen offset:1024 sc1
  v_mfma_f32_32x32x16_bf16 v[64:79], a[64:67], v[164:167], v[64:79]
  v_mfma_f32_32x32x16_bf16 v[80:95], a[68:71], v[164:167], v[80:95]
  s_waitcnt vmcnt(8)
  v_mfma_f32_32x32x16_bf16 v[32:47], a[72:75], v[168:171], v[32:47]
  buffer_load_dwordx4 v[112:115], v4, s[4:7], s30 offen offset:2048 sc1
  v_mfma_f32_32x32x16_bf16 v[48:63], a[76:79], v[168:171], v[48:63]
  buffer_load_dwordx4 v[116:119], v4, s[4:7], s31 offen offset:2048 sc1
  v_mfma_f32_32x32x16_bf16 v[64:79], a[72:75], v[172:175], v[64:79]
  v_mfma_f32_32x32x16_bf16 v[80:95], a[76:79], v[172:175], v[80:95]
  s_waitcnt vmcnt(8)
  v_mfma_f32_32x32x16_bf16 v[32:47], a[80:83], v[176:179], v[32:47]
  buffer_load_dwordx4 v[120:123], v4, s[4:7], s30 offen offset:3072 sc1
  v_mfma_f32_32x32x16_bf16 v[48:63], a[84:87], v[176:179], v[48:63]
  buffer_load_dwordx4 v[124:127], v4, s[4:7], s31 offen offset:3072 sc1
  s_add_u32 s30, s30, 4096
  s_add_u32 s31, s31, 4096
  v_mfma_f32_32x32x16_bf16 v[64:79], a[80:83], v[180:183], v[64:79]
  v_mfma_f32_32x32x16_bf16 v[80:95], a[84:87], v[180:183], v[80:95]
  s_waitcnt vmcnt(8)
  v_mfma_f32_32x32x16_bf16 v[32:47], a[88:91], v[184:187], v[32:47]
  buffer_load_dwordx4 v[128:131], v4, s[4:7], s30 offen offset:0 sc1
  v_mfma_f32_32x32x16_bf16 v[48:63], a[92:95], v[184:187], v[48:63]
  buffer_load_dwordx4 v[132:135], v4, s[4:7], s31 offen offset:0 sc1
  v_mfma_f32_32x32x16_bf16 v[64:79], a[88:91], v[188:191], v[64:79]
  v_mfma_f32_32x32x16_bf16 v[80:95], a[92:95], v[188:191], v[80:95]
  s_waitcnt vmcnt(8)
  v_mfma_f32_32x32x16_bf16 v[32:47], a[96:99], v[96:99], v[32:47]
  buffer_load_dwordx4 v[136:139], v4, s[4:7], s30 offen offset:1024 sc1
  v_mfma_f32_32x32x16_bf16 v[48:63], a[100:103], v[96:99], v[48:63]
  buffer_load_dwordx4 v[140:143], v4, s[4:7], s31 offen offset:1024 sc1
  v_mfma_f32_32x32x16_bf16 v[64:79], a[96:99], v[100:103], v[64:79]
  v_mfma_f32_32x32x16_bf16 v[80:95], a[100:103], v[100:103], v[80:95]
  s_waitcnt vmcnt(8)
  v_mfma_f32_32x32x16_bf16 v[32:47], a[104:107], v[104:107], v[32:47]
  buffer_load_dwordx4 v[144:147], v4, s[4:7], s30 offen offset:2048 sc1
  v_mfma_f32_32x32x16_bf16 v[48:63], a[108:111], v[104:107], v[48:63]
  buffer_load_dwordx4 v[148:151], v4, s[4:7], s31 offen offset:2048 sc1
  v_mfma_f32_32x32x16_bf16 v[64:79], a[104:107], v[108:111], v[64:79]
  v_mfma_f32_32x32x16_bf16 v[80:95], a[108:111], v[108:111], v[80:95]
  s_waitcnt vmcnt(8)
  v_mfma_f32_32x32x16_bf16 v[32:47], a[112:115], v[112:115], v[32:47]
  buffer_load_dwordx4 v[152:155], v4, s[4:7], s30 offen offset:3072 sc1
  v_mfma_f32_32x32x16_bf16 v[48:63], a[116:119], v[112:115], v[48:63]
  buffer_load_dwordx4 v[156:159], v4, s[4:7], s31 offen offset:3072 sc1
  s_add_u32 s30, s30, 4096
  s_add_u32 s31, s31, 4096
  v_mfma_f32_32x32x16_bf16 v[64:79], a[112:115], v[116:119], v[64:79]
  v_mfma_f32_32x32x16_bf16 v[80:95], a[116:119], v[116:119], v[80:95]
  s_waitcnt vmcnt(8)
  v_mfma_f32_32x32x16_bf16 v[32:47], a[120:123], v[120:123], v[32:47]
  buffer_load_dwordx4 v[160:163], v4, s[4:7], s30 offen offset:0 sc1
  v_mfma_f32_32x32x16_bf16 v[48:63], a[124:127], v[120:123], v[48:63]
  buffer_load_dwordx4 v[164:167], v4, s[4:7], s31 offen offset:0 sc1
  v_mfma_f32_32x32x16_bf16 v[64:79], a[120:123], v[124:127], v[64:79]
  v_mfma_f32_32x32x16_bf16 v[80:95], a[124:127], v[124:127], v[80:95]
  s_waitcnt vmcnt(8)
  v_mfma_f32_32x32x16_bf16 v[32:47], a[128:131], v[128:131], v[32:47]
  buffer_load_dwordx4 v[168:171], v4, s[4:7], s30 offen offset:1024 sc1
  v_mfma_f32_32x32x16_bf16 v[48:63], a[132:135], v[128:131], v[48:63]
  buffer_load_dwordx4 v[172:175], v4, s[4:7], s31 offen offset:1024 sc1
  v_mfma_f32_32x32x16_bf16 v[64:79], a[128:131], v[132:135], v[64:79]
  v_mfma_f32_32x32x16_bf16 v[80:95], a[132:135], v[132:135], v[80:95]
  s_waitcnt vmcnt(8)
  v_mfma_f32_32x32x16_bf16 v[32:47], a[136:139], v[136:139], v[32:47]
  buffer_load_dwordx4 v[176:179], v4, s[4:7], s30 offen offset:2048 sc1
  v_mfma_f32_32x32x16_bf16 v[48:63], a[140:143], v[136:139], v[48:63]
  buffer_load_dwordx4 v[180:183], v4, s[4:7], s31 offen offset:2048 sc1
  v_mfma_f32_32x32x16_bf16 v[64:79], a[136:139], v[140:143], v[64:79]
  v_mfma_f32_32x32x16_bf16 v[80:95], a[140:143], v[140:143], v[80:95]
  s_waitcnt vmcnt(8)
  v_mfma_f32_32x32x16_bf16 v[32:47], a[144:147], v[144:147], v[32:47]
  buffer_load_dwordx4 v[184:187], v4, s[4:7], s30 offen offset:3072 sc1
  v_mfma_f32_32x32x16_bf16 v[48:63], a[148:151], v[144:147], v[48:63]
  buffer_load_dwordx4 v[188:191], v4, s[4:7], s31 offen offset:3072 sc1
  s_add_u32 s30, s30, 4096
  s_add_u32 s31, s31, 4096
  v_mfma_f32_32x32x16_bf16 v[64:79], a[144:147], v[148:151], v[64:79]
  v_mfma_f32_32x32x16_bf16 v[80:95], a[148:151], v[148:151], v[80:95]
  s_waitcnt vmcnt(8)
  v_mfma_f32_32x32x16_bf16 v[32:47], a[152:155], v[152:155], v[32:47]
  buffer_load_dwordx4 v[96:99], v4, s[4:7], s30 offen offset:0 sc1
  v_mfma_f32_32x32x16_bf16 v[48:63], a[156:159], v[152:155], v[48:63]
  buffer_load_dwordx4 v[100:103], v4, s[4:7], s31 offen offset:0 sc1
  v_mfma_f32_32x32x16_bf16 v[64:79], a[152:155], v[156:159], v[64:79]
  v_mfma_f32_32x32x16_bf16 v[80:95], a[156:159], v[156:159], v[80:95]
  s_waitcnt vmcnt(8)
  v_mfma_f32_32x32x16_bf16 v[32:47], a[160:163], v[160:163], v[32:47]
  buffer_load_dwordx4 v[104:107], v4, s[4:7], s30 offen offset:1024 sc1
  v_mfma_f32_32x32x16_bf16 v[48:63], a[164:167], v[160:163], v[48:63]
  buffer_load_dwordx4 v[108:111], v4, s[4:7], s31 offen offset:1024 sc1
  v_mfma_f32_32x32x16_bf16 v[64:79], a[160:163], v[164:167], v[64:79]
  v_mfma_f32_32x32x16_bf16 v[80:95], a[164:167], v[164:167], v[80:95]
  s_waitcnt vmcnt(8)
  v_mfma_f32_32x32x16_bf16 v[32:47], a[168:171], v[168:171], v[32:47]
  buffer_load_dwordx4 v[112:115], v4, s[4:7], s30 offen offset:2048 sc1
  v_mfma_f32_32x32x16_bf16 v[48:63], a[172:175], v[168:171], v[48:63]
  buffer_load_dwordx4 v[116:119], v4, s[4:7], s31 offen offset:2048 sc1
  v_mfma_f32_32x32x16_bf16 v[64:79], a[168:171], v[172:175], v[64:79]
  v_mfma_f32_32x32x16_bf16 v[80:95], a[172:175], v[172:175], v[80:95]
  s_waitcnt vmcnt(8)
  v_mfma_f32_32x32x16_bf16 v[32:47], a[176:179], v[176:179], v[32:47]
  buffer_load_dwordx4 v[120:123], v4, s[4:7], s30 offen offset:3072 sc1
  v_mfma_f32_32x32x16_bf16 v[48:63], a[180:183], v[176:179], v[48:63]
  buffer_load_dwordx4 v[124:127], v4, s[4:7], s31 offen offset:3072 sc1
  s_add_u32 s30, s30, 4096
  s_add_u32 s31, s31, 4096
  v_mfma_f32_32x32x16_bf16 v[64:79], a[176:179], v[180:183], v[64:79]
  v_mfma_f32_32x32x16_bf16 v[80:95], a[180:183], v[180:183], v[80:95]
  s_waitcnt vmcnt(8)
  v_mfma_f32_32x32x16_bf16 v[32:47], a[184:187], v[184:187], v[32:47]
  s_add_u32 s38, s37, s21
  buffer_load_dwordx4 v[16:19], v4, s[4:7], s38 offen sc1
  buffer_load_dwordx4 v[20:23], v4, s[4:7], s38 offen offset:1024 sc1
  v_lshlrev_b32 v6, 4, v3
  s_lshl_b32 s38, s36, 7
  s_add_u32 s38, s38, 0x4d6000
  buffer_load_dwordx4 v[192:195], v6, s[4:7], s38 offen offset:0
  buffer_load_dwordx4 v[196:199], v6, s[4:7], s38 offen offset:32
  buffer_load_dwordx4 v[200:203], v6, s[4:7], s38 offen offset:64
  buffer_load_dwordx4 v[204:207], v6, s[4:7], s38 offen offset:96
  v_mfma_f32_32x32x16_bf16 v[48:63], a[188:191], v[184:187], v[48:63]
  v_mfma_f32_32x32x16_bf16 v[64:79], a[184:187], v[188:191], v[64:79]
  v_mfma_f32_32x32x16_bf16 v[80:95], a[188:191], v[188:191], v[80:95]
  s_waitcnt vmcnt(12)
  v_mfma_f32_32x32x16_bf16 v[32:47], a[192:195], v[96:99], v[32:47]
  s_mov_b32 m0, s45
  s_add_u32 s45, s45, 12288
  buffer_load_dwordx4 v4, s[4:7], s44 offen offset:0 lds
  v_mfma_f32_32x32x16_bf16 v[48:63], a[196:199], v[96:99], v[48:63]
  buffer_load_dwordx4 v4, s[4:7], s44 offen offset:1024 lds
  v_mfma_f32_32x32x16_bf16 v[64:79], a[192:195], v[100:103], v[64:79]
  buffer_load_dwordx4 v4, s[4:7], s44 offen offset:2048 lds
  s_add_u32 s44, s44, 12288
  v_mfma_f32_32x32x16_bf16 v[80:95], a[196:199], v[100:103], v[80:95]
  s_mov_b32 m0, s45
  s_add_u32 s45, s45, 12288
  buffer_load_dwordx4 v4, s[4:7], s44 offen offset:0 lds
  s_waitcnt vmcnt(14)
  v_mfma_f32_32x32x16_bf16 v[32:47], a[200:203], v[104:107], v[32:47]
  buffer_load_dwordx4 v4, s[4:7], s44 offen offset:1024 lds
  v_mfma_f32_32x32x16_bf16 v[48:63], a[204:207], v[104:107], v[48:63]
  buffer_load_dwordx4 v4, s[4:7], s44 offen offset:2048 lds
  s_add_u32 s44, s44, 12288
  v_mfma_f32_32x32x16_bf16 v[64:79], a[200:203], v[108:111], v[64:79]
  s_mov_b32 m0, s45
  s_add_u32 s45, s45, 12288
  buffer_load_dwordx4 v4, s[4:7], s44 offen offset:0 lds
  v_mfma_f32_32x32x16_bf16 v[80:95], a[204:207], v[108:111], v[80:95]
  buffer_load_dwordx4 v4, s[4:7], s44 offen offset:1024 lds
  s_waitcnt vmcnt(16)
  v_mfma_f32_32x32x16_bf16 v[32:47], a[208:211], v[112:115], v[32:47]
  buffer_load_dwordx4 v4, s[4:7], s44 offen offset:2048 lds
  s_add_u32 s44, s44, 12288
  v_mfma_f32_32x32x16_bf16 v[48:63], a[212:215], v[112:115], v[48:63]
  s_mov_b32 m0, s45
  s_add_u32 s45, s45, 12288
  buffer_load_dwordx4 v4, s[4:7], s44 offen offset:0 lds
  v_mfma_f32_32x32x16_bf16 v[64:79], a[208:211], v[116:119], v[64:79]
  buffer_load_dwordx4 v4, s[4:7], s44 offen offset:1024 lds
  v_mfma_f32_32x32x16_bf16 v[80:95], a[212:215], v[116:119], v[80:95]
  buffer_load_dwordx4 v4, s[4:7], s44 offen offset:2048 lds
  s_add_u32 s44, s44, 12288
  s_waitcnt vmcnt(18)
  v_mfma_f32_32x32x16_bf16 v[32:47], a[216:219], v[120:123], v[32:47]
  s_mov_b32 m0, s45
  s_add_u32 s45, s45, 12288
  buffer_load_dwordx4 v4, s[4:7], s44 offen offset:0 lds
  v_mfma_f32_32x32x16_bf16 v[48:63], a[220:223], v[120:123], v[48:63]
  buffer_load_dwordx4 v4, s[4:7], s44 offen offset:1024 lds
  v_mfma_f32_32x32x16_bf16 v[64:79], a[216:219], v[124:127], v[64:79]
  buffer_load_dwordx4 v4, s[4:7], s44 offen offset:2048 lds
  s_add_u32 s44, s44, 12288
  v_mfma_f32_32x32x16_bf16 v[80:95], a[220:223], v[124:127], v[80:95]
  s_mov_b32 m0, s45
  s_add_u32 s45, s45, 12288
  buffer_load_dwordx4 v4, s[4:7], s44 offen offset:0 lds
  buffer_load_dwordx4 v4, s[4:7], s44 offen offset:1024 lds
  buffer_load_dwordx4 v4, s[4:7], s44 offen offset:2048 lds
  s_add_u32 s44, s44, 12288
  s_mov_b32 m0, s45
  s_add_u32 s45, s45, 12288
  buffer_load_dwordx4 v4, s[4:7], s44 offen offset:0 lds
  buffer_load_dwordx4 v4, s[4:7], s44 offen offset:1024 lds
  buffer_load_dwordx4 v4, s[4:7], s44 offen offset:2048 lds
  s_add_u32 s44, s44, 12288
  s_nop 7
  s_nop 7
  v_add_u32 v5, 114688, v4
  s_cmp_eq_u32 s3, 0
  s_cbranch_scc1 red_36
  s_cmp_eq_u32 s3, 1
  s_cbranch_scc1 red_37
  s_cmp_eq_u32 s3, 2
  s_cbranch_scc1 red_38
  ds_write_b128 v5, v[32:35] offset:8192
  ds_write_b128 v5, v[36:39] offset:9216
  ds_write_b128 v5, v[40:43] offset:10240
  ds_write_b128 v5, v[44:47] offset:11264
  ds_write_b128 v5, v[48:51] offset:16384
  ds_write_b128 v5, v[52:55] offset:17408
  ds_write_b128 v5, v[56:59] offset:18432
  ds_write_b128 v5, v[60:63] offset:19456
  ds_write_b128 v5, v[64:67] offset:24576
  ds_write_b128 v5, v[68:71] offset:25600
  ds_write_b128 v5, v[72:75] offset:26624
  ds_write_b128 v5, v[76:79] offset:27648
  s_waitcnt lgkmcnt(0)
  v_mov_b32 v32, v80
  v_mov_b32 v33, v81
  v_mov_b32 v34, v82
  v_mov_b32 v35, v83
  v_mov_b32 v36, v84
  v_mov_b32 v37, v85
  v_mov_b32 v38, v86
  v_mov_b32 v39, v87
  v_mov_b32 v40, v88
  v_mov_b32 v41, v89
  v_mov_b32 v42, v90
  v_mov_b32 v43, v91
  v_mov_b32 v44, v92
  v_mov_b32 v45, v93
  v_mov_b32 v46, v94
  v_mov_b32 v47, v95
  s_branch redj_35
red_36:
  ds_write_b128 v5, v[48:51] offset:20480
  ds_write_b128 v5, v[52:55] offset:21504
  ds_write_b128 v5, v[56:59] offset:22528
  ds_write_b128 v5, v[60:63] offset:23552
  ds_write_b128 v5, v[64:67] offset:28672
  ds_write_b128 v5, v[68:71] offset:29696
  ds_write_b128 v5, v[72:75] offset:30720
  ds_write_b128 v5, v[76:79] offset:31744
  ds_write_b128 v5, v[80:83] offset:36864
  ds_write_b128 v5, v[84:87] offset:37888
  ds_write_b128 v5, v[88:91] offset:38912
  ds_write_b128 v5, v[92:95] offset:39936
  s_branch redj_35
red_37:
  ds_write_b128 v5, v[32:35] offset:0
  ds_write_b128 v5, v[36:39] offset:1024
  ds_write_b128 v5, v[40:43] offset:2048
  ds_write_b128 v5, v[44:47] offset:3072
  ds_write_b128 v5, v[64:67] offset:32768
  ds_write_b128 v5, v[68:71] offset:33792
  ds_write_b128 v5, v[72:75] offset:34816
  ds_write_b128 v5, v[76:79] offset:35840
  ds_write_b128 v5, v[80:83] offset:40960
  ds_write_b128 v5, v[84:87] offset:41984
  ds_write_b128 v5, v[88:91] offset:43008
  ds_write_b128 v5, v[92:95] offset:44032
  s_waitcnt lgkmcnt(0)
  v_mov_b32 v32, v48
  v_mov_b32 v33, v49
  v_mov_b32 v34, v50
  v_mov_b32 v35, v51
  v_mov_b32 v36, v52
  v_mov_b32 v37, v53
  v_mov_b32 v38, v54
  v_mov_b32 v39, v55
  v_mov_b32 v40, v56
  v_mov_b32 v41, v57
  v_mov_b32 v42, v58
  v_mov_b32 v43, v59
  v_mov_b32 v44, v60
  v_mov_b32 v45, v61
  v_mov_b32 v46, v62
  v_mov_b32 v47, v63
  s_branch redj_35
red_38:
  ds_write_b128 v5, v[32:35] offset:4096
  ds_write_b128 v5, v[36:39] offset:5120
  ds_write_b128 v5, v[40:43] offset:6144
  ds_write_b128 v5, v[44:47] offset:7168
  ds_write_b128 v5, v[48:51] offset:12288
  ds_write_b128 v5, v[52:55] offset:13312
  ds_write_b128 v5, v[56:59] offset:14336
  ds_write_b128 v5, v[60:63] offset:15360
  ds_write_b128 v5, v[80:83] offset:45056
  ds_write_b128 v5, v[84:87] offset:46080
  ds_write_b128 v5, v[88:91] offset:47104
  ds_write_b128 v5, v[92:95] offset:48128
  s_waitcnt lgkmcnt(0)
  v_mov_b32 v32, v64
  v_mov_b32 v33, v65
  v_mov_b32 v34, v66
  v_mov_b32 v35, v67
  v_mov_b32 v36, v68
  v_mov_b32 v37, v69
  v_mov_b32 v38, v70
  v_mov_b32 v39, v71
  v_mov_b32 v40, v72
  v_mov_b32 v41, v73
  v_mov_b32 v42, v74
  v_mov_b32 v43, v75
  v_mov_b32 v44, v76
  v_mov_b32 v45, v77
  v_mov_b32 v46, v78
  v_mov_b32 v47, v79
redj_35:
  s_mul_i32 s30, s3, 12288
  v_add_u32 v5, s30, v5
  s_waitcnt lgkmcnt(0)
  s_barrier
  ds_read_b128 v[208:211], v5 offset:0
  ds_read_b128 v[212:215], v5 offset:1024
  ds_read_b128 v[216:219], v5 offset:2048
  ds_read_b128 v[220:223], v5 offset:3072
  ds_read_b128 v[224:227], v5 offset:4096
  ds_read_b128 v[228:231], v5 offset:5120
  ds_read_b128 v[232:235], v5 offset:6144
  ds_read_b128 v[236:239], v5 offset:7168
  ds_read_b128 v[240:243], v5 offset:8192
  ds_read_b128 v[244:247], v5 offset:9216
  ds_read_b128 v[248:251], v5 offset:10240
  ds_read_b128 v[252:255], v5 offset:11264
  s_waitcnt lgkmcnt(8)
  v_pk_add_f32 v[32:33], v[32:33], v[208:209]
  v_pk_add_f32 v[34:35], v[34:35], v[210:211]
  v_pk_add_f32 v[36:37], v[36:37], v[212:213]
  v_pk_add_f32 v[38:39], v[38:39], v[214:215]
  v_pk_add_f32 v[40:41], v[40:41], v[216:217]
  v_pk_add_f32 v[42:43], v[42:43], v[218:219]
  v_pk_add_f32 v[44:45], v[44:45], v[220:221]
  v_pk_add_f32 v[46:47], v[46:47], v[222:223]
  s_waitcnt lgkmcnt(4)
  v_pk_add_f32 v[32:33], v[32:33], v[224:225]
  v_pk_add_f32 v[34:35], v[34:35], v[226:227]
  v_pk_add_f32 v[36:37], v[36:37], v[228:229]
  v_pk_add_f32 v[38:39], v[38:39], v[230:231]
  v_pk_add_f32 v[40:41], v[40:41], v[232:233]
  v_pk_add_f32 v[42:43], v[42:43], v[234:235]
  v_pk_add_f32 v[44:45], v[44:45], v[236:237]
  v_pk_add_f32 v[46:47], v[46:47], v[238:239]
  s_waitcnt lgkmcnt(0)
  v_pk_add_f32 v[32:33], v[32:33], v[240:241]
  v_pk_add_f32 v[34:35], v[34:35], v[242:243]
  v_pk_add_f32 v[36:37], v[36:37], v[244:245]
  v_pk_add_f32 v[38:39], v[38:39], v[246:247]
  v_pk_add_f32 v[40:41], v[40:41], v[248:249]
  v_pk_add_f32 v[42:43], v[42:43], v[250:251]
  v_pk_add_f32 v[44:45], v[44:45], v[252:253]
  v_pk_add_f32 v[46:47], v[46:47], v[254:255]
  s_waitcnt vmcnt(21)
  v_pk_add_f32 v[32:33], v[32:33], v[192:193]
  v_pk_add_f32 v[34:35], v[34:35], v[194:195]
  v_pk_add_f32 v[36:37], v[36:37], v[196:197]
  v_pk_add_f32 v[38:39], v[38:39], v[198:199]
  v_pk_add_f32 v[40:41], v[40:41], v[200:201]
  v_pk_add_f32 v[42:43], v[42:43], v[202:203]
  v_pk_add_f32 v[44:45], v[44:45], v[204:205]
  v_pk_add_f32 v[46:47], v[46:47], v[206:207]
  v_lshlrev_b32 v208, 16, v16
  v_and_b32 v209, 0xffff0000, v16
  v_lshlrev_b32 v210, 16, v17
  v_and_b32 v211, 0xffff0000, v17
  v_lshlrev_b32 v212, 16, v18
  v_and_b32 v213, 0xffff0000, v18
  v_lshlrev_b32 v214, 16, v19
  v_and_b32 v215, 0xffff0000, v19
  v_lshlrev_b32 v216, 16, v20
  v_and_b32 v217, 0xffff0000, v20
  v_lshlrev_b32 v218, 16, v21
  v_and_b32 v219, 0xffff0000, v21
  v_lshlrev_b32 v220, 16, v22
  v_and_b32 v221, 0xffff0000, v22
  v_lshlrev_b32 v222, 16, v23
  v_and_b32 v223, 0xffff0000, v23
  v_pk_add_f32 v[32:33], v[32:33], v[208:209]
  v_pk_add_f32 v[34:35], v[34:35], v[210:211]
  v_pk_add_f32 v[36:37], v[36:37], v[212:213]
  v_pk_add_f32 v[38:39], v[38:39], v[214:215]
  v_pk_add_f32 v[40:41], v[40:41], v[216:217]
  v_pk_add_f32 v[42:43], v[42:43], v[218:219]
  v_pk_add_f32 v[44:45], v[44:45], v[220:221]
  v_pk_add_f32 v[46:47], v[46:47], v[222:223]
  s_cmp_eq_u32 s14, 1
  s_cbranch_scc1 fin_40
  v_pk_add_f32 v[208:209], v[32:33], v[34:35]
  v_pk_mul_f32 v[210:211], v[32:33], v[32:33]
  v_pk_fma_f32 v[210:211], v[34:35], v[34:35], v[210:211]
  v_pk_add_f32 v[208:209], v[208:209], v[36:37]
  v_pk_fma_f32 v[210:211], v[36:37], v[36:37], v[210:211]
  v_pk_add_f32 v[208:209], v[208:209], v[38:39]
  v_pk_fma_f32 v[210:211], v[38:39], v[38:39], v[210:211]
  v_pk_add_f32 v[208:209], v[208:209], v[40:41]
  v_pk_fma_f32 v[210:211], v[40:41], v[40:41], v[210:211]
  v_pk_add_f32 v[208:209], v[208:209], v[42:43]
  v_pk_fma_f32 v[210:211], v[42:43], v[42:43], v[210:211]
  v_pk_add_f32 v[208:209], v[208:209], v[44:45]
  v_pk_fma_f32 v[210:211], v[44:45], v[44:45], v[210:211]
  v_pk_add_f32 v[208:209], v[208:209], v[46:47]
  v_pk_fma_f32 v[210:211], v[46:47], v[46:47], v[210:211]
  v_add_f32 v212, v208, v209
  v_add_f32 v213, v210, v211
  v_mov_b32 v214, v212
  v_mov_b32 v215, v213
  v_cvt_pk_bf16_f32 v32, v32, v33
  v_cvt_pk_bf16_f32 v33, v34, v35
  v_cvt_pk_bf16_f32 v34, v36, v37
  v_cvt_pk_bf16_f32 v35, v38, v39
  v_cvt_pk_bf16_f32 v36, v40, v41
  v_cvt_pk_bf16_f32 v37, v42, v43
  v_cvt_pk_bf16_f32 v38, v44, v45
  v_cvt_pk_bf16_f32 v39, v46, v47
  s_add_u32 s38, s37, s24
  buffer_store_dwordx4 v[32:35], v4, s[4:7], s38 offen
  buffer_store_dwordx4 v[36:39], v4, s[4:7], s38 offen offset:1024
  v_permlane32_swap_b32 v212, v214
  v_permlane32_swap_b32 v213, v215
  v_lshlrev_b32 v5, 3, v2
  s_lshl_b32 s38, s36, 14
  s_lshl_b32 s39, s35, 8
  s_add_u32 s38, s38, s39
  s_add_u32 s38, s38, s25
  v_add_f32 v212, v212, v214
  v_add_f32 v213, v213, v215
  buffer_store_dwordx2 v[212:213], v5, s[4:7], s38 offen
  s_branch bend_41
fin_40:
  v_cvt_pk_bf16_f32 v32, v32, v33
  v_cvt_pk_bf16_f32 v33, v34, v35
  v_cvt_pk_bf16_f32 v34, v36, v37
  v_cvt_pk_bf16_f32 v35, v38, v39
  v_cvt_pk_bf16_f32 v36, v40, v41
  v_cvt_pk_bf16_f32 v37, v42, v43
  v_cvt_pk_bf16_f32 v38, v44, v45
  v_cvt_pk_bf16_f32 v39, v46, v47
  v_mul_u32_u24 v5, 896, v2
  v_lshl_add_u32 v5, v3, 3, v5
  s_mul_i32 s38, s35, 28672
  s_lshl_b32 s39, s36, 6
  s_add_u32 s38, s38, s39
  buffer_store_dwordx2 v[32:33], v5, s[8:11], s38 offen offset:0
  buffer_store_dwordx2 v[34:35], v5, s[8:11], s38 offen offset:16
  buffer_store_dwordx2 v[36:37], v5, s[8:11], s38 offen offset:32
  buffer_store_dwordx2 v[38:39], v5, s[8:11], s38 offen offset:48
bend_41:
  s_branch ffn2_done
ffn2_skip:
  s_cmp_eq_u32 s14, 1
  s_cbranch_scc1 ffn2_done
  s_lshr_b32 s44, s13, 1
  s_mul_i32 s44, s44, 86016
  s_mul_i32 s45, s3, 3072
  s_add_u32 s44, s44, s45
  s_add_u32 s44, s44, 0x0
  s_mov_b32 m0, s45
  s_add_u32 s45, s45, 12288
  buffer_load_dwordx4 v4, s[4:7], s44 offen offset:0 lds
  buffer_load_dwordx4 v4, s[4:7], s44 offen offset:1024 lds
  buffer_load_dwordx4 v4, s[4:7], s44 offen offset:2048 lds
  s_add_u32 s44, s44, 12288
  s_mov_b32 m0, s45
  s_add_u32 s45, s45, 12288
  buffer_load_dwordx4 v4, s[4:7], s44 offen offset:0 lds
  buffer_load_dwordx4 v4, s[4:7], s44 offen offset:1024 lds
  buffer_load_dwordx4 v4, s[4:7], s44 offen offset:2048 lds
  s_add_u32 s44, s44, 12288
  s_mov_b32 m0, s45
  s_add_u32 s45, s45, 12288
  buffer_load_dwordx4 v4, s[4:7], s44 offen offset:0 lds
  buffer_load_dwordx4 v4, s[4:7], s44 offen offset:1024 lds
  buffer_load_dwordx4 v4, s[4:7], s44 offen offset:2048 lds
  s_add_u32 s44, s44, 12288
  s_mov_b32 m0, s45
  s_add_u32 s45, s45, 12288
  buffer_load_dwordx4 v4, s[4:7], s44 offen offset:0 lds
  buffer_load_dwordx4 v4, s[4:7], s44 offen offset:1024 lds
  buffer_load_dwordx4 v4, s[4:7], s44 offen offset:2048 lds
  s_add_u32 s44, s44, 12288
  s_mov_b32 m0, s45
  s_add_u32 s45, s45, 12288
  buffer_load_dwordx4 v4, s[4:7], s44 offen offset:0 lds
  buffer_load_dwordx4 v4, s[4:7], s44 offen offset:1024 lds
  buffer_load_dwordx4 v4, s[4:7], s44 offen offset:2048 lds
  s_add_u32 s44, s44, 12288
  s_mov_b32 m0, s45
  s_add_u32 s45, s45, 12288
  buffer_load_dwordx4 v4, s[4:7], s44 offen offset:0 lds
  buffer_load_dwordx4 v4, s[4:7], s44 offen offset:1024 lds
  buffer_load_dwordx4 v4, s[4:7], s44 offen offset:2048 lds
  s_add_u32 s44, s44, 12288
  s_mov_b32 m0, s45
  s_add_u32 s45, s45, 12288
  buffer_load_dwordx4 v4, s[4:7], s44 offen offset:0 lds
  buffer_load_dwordx4 v4, s[4:7], s44 offen offset:1024 lds
  buffer_load_dwordx4 v4, s[4:7], s44 offen offset:2048 lds
  s_add_u32 s44, s44, 12288
ffn2_done:
  s_cmp_eq_u32 s14, 1
  s_cbranch_scc1 main_fin
  s_waitcnt vmcnt(0) lgkmcnt(0)
  s_barrier
  s_add_u32 s15, s15, 1
  s_cmp_lg_u32 s3, 0
  s_cbranch_scc1 lb_end_42
  v_lshlrev_b32 v5, 2, v2
  s_lshl_b32 s40, s12, 7
  s_mov_b32 s42, 0
  s_cmp_lg_u32 s15, 1
  s_cbranch_scc1 lb_known_46
  s_add_u32 s41, s40, 0x4e0000
lb_px_47:
  s_add_u32 s42, s42, 1
  s_cmp_gt_u32 s42, 0x40000
  s_cbranch_scc1 lb_known_46
  buffer_load_dword v6, v5, s[4:7], s41 offen sc0 sc1
  s_waitcnt vmcnt(0)
  v_and_b32 v7, -16, v6
  v_cmp_ne_u32 vcc, s67, v7
  s_cbranch_vccnz lb_px_47
  v_readfirstlane_b32 s43, v6
  s_nop 1
  v_cmp_ne_u32 vcc, s43, v6
  s_mov_b32 s16, 0
  s_cbranch_vccnz lb_known_46
  s_mov_b32 s16, 1
lb_known_46:
  s_add_u32 s41, s40, 0x4e1000
  s_lshl_b32 s43, s13, 2
  s_add_u32 s43, s43, s41
  s_add_u32 s40, s67, s15
  v_mov_b32 v6, s40
  v_mov_b32 v7, 0
  s_mov_b32 s42, 0
  s_cmp_eq_u32 s16, 0
  s_cbranch_scc1 lb_slow_43
  s_mov_b64 exec, 1
  buffer_store_dword v6, v7, s[4:7], s43 offen
  s_mov_b64 exec, -1
lb_poll_44:
  s_add_u32 s42, s42, 1
  s_cmp_gt_u32 s42, 0x40000
  s_cbranch_scc1 lb_end_42
  buffer_load_dword v6, v5, s[4:7], s41 offen sc1
  s_waitcnt vmcnt(0)
  v_subrev_u32 v6, s40, v6
  v_cmp_le_u32 vcc, 8, v6
  s_cbranch_vccnz lb_poll_44
  s_branch lb_end_42
lb_slow_43:
  buffer_wbl2 sc1
  s_waitcnt vmcnt(0)
  s_mov_b64 exec, 1
  buffer_store_dword v6, v7, s[4:7], s43 offen sc0 sc1
  s_mov_b64 exec, -1
lb_poll2_45:
  s_add_u32 s42, s42, 1
  s_cmp_gt_u32 s42, 0x40000
  s_cbranch_scc1 lb_done_48
  buffer_load_dword v6, v5, s[4:7], s41 offen sc0 sc1
  s_waitcnt vmcnt(0)
  v_subrev_u32 v6, s40, v6
  v_cmp_le_u32 vcc, 8, v6
  s_cbranch_vccnz lb_poll2_45
lb_done_48:
  buffer_inv sc1
  s_waitcnt vmcnt(0)
lb_end_42:
  s_barrier
  s_mov_b32 s14, 1
  s_branch layer_loop
main_fin:
main_end:
  s_endpgm
main_code_end:
.section .rodata,"a"
.p2align 6
.amdhsa_kernel interleave_layers__mha_block__dense_activation_gelu__prompt_kernel
  .amdhsa_next_free_vgpr 512
  .amdhsa_next_free_sgpr 102
  .amdhsa_accum_offset 256
  .amdhsa_group_segment_fixed_size 0
  .amdhsa_kernarg_size 88
  .amdhsa_user_sgpr_count 2
  .amdhsa_user_sgpr_kernarg_segment_ptr 1
  .amdhsa_system_sgpr_workgroup_id_x 1
.end_amdhsa_kernel
```
